```python
import torch

def _softmax(x, axis=-1):
    return torch.softmax(x, dim=axis)
def _gelu(x):
    return torch.nn.functional.gelu(x, approximate="tanh")
def _silu(x):
    return torch.nn.functional.silu(x)
def _sigmoid(x):
    return torch.sigmoid(x)
def _layernorm(x, axis=-1, eps=1e-5):
    m = x.mean(dim=axis, keepdim=True)
    v = x.var(dim=axis, keepdim=True, unbiased=False)
    return (x - m) / torch.sqrt(v + eps)
def _scatter_add(tgt, idx, src, axis=0):
    return tgt.clone().index_add_(axis, idx, src)
def _segment_sum(src, seg, n):
    out = torch.zeros((n,) + src.shape[1:], dtype=src.dtype)
    return out.index_add_(0, seg, src)
def _pad(x, pw):
    flat = tuple(v for pair in reversed(pw) for v in pair)
    return torch.nn.functional.pad(x, flat)

kernel_name = 'gated_mix__sliding_block__dense_activation_relu__prompt'

def setup_inputs():

    _w = (lambda a: (lambda t: t.to(torch.bfloat16) if t.is_floating_point() else t)(torch.as_tensor(a)))
    def _A_setup():
        B, S, D = 1, 2048, 640
        return {
            "x": _w((lambda *s: torch.randn(*s, dtype=torch.bfloat16) * 0.05)(B, S, D)),
            "wqkv": _w((lambda *s: torch.randn(*s, dtype=torch.bfloat16) * 1.6)(D, 3 * D)),
            "wo": _w((lambda *s: torch.randn(*s, dtype=torch.bfloat16) * 0.05)(D, D)),
        }
    _A_in = _A_setup()

    def _B_setup():
        B, S, D, Dff = 1, 2048, 640, 1536
        return {
            "x": _w((lambda *s: torch.randn(*s, dtype=torch.bfloat16) * 0.05)(B, S, D)),
            "w1": _w((lambda *s: torch.randn(*s, dtype=torch.bfloat16) * 0.2)(D, Dff)),
            "w2": _w((lambda *s: torch.randn(*s, dtype=torch.bfloat16) * 0.2)(Dff, D)),
        }
    _B_in = _B_setup()

    return {
        "A_x": _A_in["x"],
        "A_wqkv": _A_in["wqkv"],
        "A_wo": _A_in["wo"],
        "B_x": _B_in["x"],
        "B_w1": _B_in["w1"],
        "B_w2": _B_in["w2"],
        "gate_w": _w((lambda *s: torch.randn(*s, dtype=torch.bfloat16) * 0.05)(640) * 16.0),
    }

def reference(A_x, A_wqkv, A_wo, B_x, B_w1, B_w2, gate_w):
    def _A_ref(x, wqkv, wo):
        B, S, D = x.shape
        H = 32; Dh = D // H; W = 256
        qkv = (lambda x, *d: x.permute(*d))((x @ wqkv).reshape(B, S, 3, H, Dh), 2, 0, 3, 1, 4)
        q, k, v = qkv[0], qkv[1], qkv[2]
        scores = torch.einsum("bhqd,bhkd->bhqk", q, k) * (Dh ** -0.5)
        idx = torch.arange(S)
        mask = (idx[:, None] - idx[None, :] >= 0) & (idx[:, None] - idx[None, :] < W)
        scores = torch.where(mask[None, None], scores, -1e9)
        p = _softmax(scores, axis=-1)
        o = torch.einsum("bhqk,bhkd->bhqd", p, v)
        return (lambda x, *d: x.permute(*d))(o, 0, 2, 1, 3).reshape(B, S, D) @ wo

    def _B_ref(x, w1, w2):
        h = torch.einsum("bsd,df->bsf", x, w1)
        zero = torch.zeros_like(h)
        h = torch.maximum(h, zero)
        return torch.einsum("bsf,fd->bsd", h, w2)

    x = A_x
    g = _sigmoid((x * gate_w).sum(-1, keepdims=True))
    a = _A_ref(x, A_wqkv, A_wo)
    b = _B_ref(x, B_w1, B_w2)
    return g * a + (1 - g) * b
```

```asm
; @launch kernel=k1_kernel grid=(256,1,1) block=(512,1,1) lds=163840
; @launch kernel=k2_kernel grid=(256,1,1) block=(512,1,1) lds=128512
.amdgcn_target "amdgcn-amd-amdhsa--gfx950"
.text
.globl k1_kernel
.p2align 8
.type k1_kernel,@function
k1_kernel:
    s_cmp_ge_u32 s2, 256
    s_cbranch_scc1 K1_done
    s_getpc_b64 s[60:61]
    s_load_dwordx2 s[4:5], s[0:1], 0
    s_load_dwordx4 s[64:67], s[0:1], 8
    s_load_dwordx4 s[24:27], s[0:1], 32
    s_load_dwordx2 s[68:69], s[0:1], 48
    s_load_dwordx2 s[28:29], s[0:1], 72
    v_lshrrev_b32 v1, 6, v0
    v_and_b32 v0, 63, v0
    v_readfirstlane_b32 s30, v1
    s_and_b32 s31, s2, 7
    s_lshr_b32 s32, s2, 3
    s_cmp_lt_u32 s32, 1
    s_cbranch_scc0 K1_nocpf
    s_cmp_lt_u32 s30, 3
    s_cbranch_scc0 K1_nocpf
    s_lshl_b32 s46, s30, 13
    v_lshlrev_b32 v10, 7, v0
    v_add_u32 v10, s46, v10
    global_load_dword v226, v10, s[60:61]
K1_nocpf:
    s_and_b32 s33, s31, 1
    s_lshl_b32 s33, s33, 3
    s_and_b32 s34, s32, 7
    s_add_u32 s33, s33, s34
    s_lshr_b32 s34, s31, 1
    s_lshl_b32 s34, s34, 2
    s_lshr_b32 s35, s32, 3
    s_add_u32 s34, s34, s35
    s_lshl_b32 s40, s33, 7
    s_cmp_lt_u32 s34, 6
    s_cbranch_scc1 K1_sec_qk
    s_cmp_lt_u32 s34, 9
    s_cbranch_scc1 K1_sec_v
    s_mov_b32 s36, 2
    s_sub_u32 s37, s34, 9
    s_mul_i32 s37, s37, 14
    s_mov_b32 s62, s37
    s_min_u32 s37, s37, 82
    s_lshl_b32 s38, s37, 5
    s_mov_b32 s39, 3072
    s_branch K1_sec_done
K1_sec_qk:
    s_mov_b32 s36, 0
    s_mul_i32 s37, s34, 14
    s_mov_b32 s62, s37
    s_min_u32 s37, s37, 66
    s_lshl_b32 s38, s37, 5
    s_mov_b32 s39, 3840
    s_branch K1_sec_done
K1_sec_v:
    s_mov_b32 s36, 1
    s_sub_u32 s37, s34, 6
    s_mul_i32 s37, s37, 14
    s_mov_b32 s62, s37
    s_min_u32 s37, s37, 26
    s_lshl_b32 s38, s37, 5
    s_add_u32 s38, s38, 2560
    s_mov_b32 s39, 3840
K1_sec_done:
    s_cmp_ge_u32 s30, 4
    s_cbranch_scc1 K1_loader

    s_and_b32 s41, s30, 1
    s_lshr_b32 s42, s30, 1
    v_and_b32 v1, 15, v0
    v_lshrrev_b32 v2, 4, v0
    v_and_b32 v3, 7, v1
    v_xor_b32 v3, v2, v3
    v_lshlrev_b32 v3, 4, v3
    v_lshl_add_u32 v3, v1, 7, v3
    s_lshl_b32 s43, s41, 13
    v_add_u32 v216, s43, v3
    v_xor_b32 v217, 64, v216
    v_lshrrev_b32 v4, 2, v1
    v_and_b32 v5, 3, v0
    v_and_b32 v6, 1, v2
    v_lshl_or_b32 v6, v6, 2, v4
    v_lshl_add_u32 v7, v2, 3, v4
    v_lshlrev_b32 v7, 9, v7
    v_lshl_add_u32 v7, v5, 3, v7
    v_add_u32 v7, 16384, v7
    s_lshl_b32 s44, s42, 3
    s_add_u32 s45, s42, 6

    s_add_u32 s46, s44, 0
    v_xor_b32 v8, s46, v6
    v_lshl_add_u32 v218, v8, 5, v7
    s_add_u32 s46, s44, 1
    v_xor_b32 v8, s46, v6
    v_lshl_add_u32 v219, v8, 5, v7
    s_add_u32 s46, s44, 2
    v_xor_b32 v8, s46, v6
    v_lshl_add_u32 v220, v8, 5, v7
    s_add_u32 s46, s44, 3
    v_xor_b32 v8, s46, v6
    v_lshl_add_u32 v221, v8, 5, v7
    s_add_u32 s46, s44, 4
    v_xor_b32 v8, s46, v6
    v_lshl_add_u32 v222, v8, 5, v7
    s_add_u32 s46, s44, 5
    v_xor_b32 v8, s46, v6
    v_lshl_add_u32 v223, v8, 5, v7
    v_xor_b32 v8, s45, v6
    v_lshl_add_u32 v224, v8, 5, v7
    v_mov_b32 v16, 0
    v_mov_b32 v17, 0
    v_mov_b32 v18, 0
    v_mov_b32 v19, 0
    v_mov_b32 v20, 0
    v_mov_b32 v21, 0
    v_mov_b32 v22, 0
    v_mov_b32 v23, 0
    v_mov_b32 v24, 0
    v_mov_b32 v25, 0
    v_mov_b32 v26, 0
    v_mov_b32 v27, 0
    v_mov_b32 v28, 0
    v_mov_b32 v29, 0
    v_mov_b32 v30, 0
    v_mov_b32 v31, 0
    v_mov_b32 v32, 0
    v_mov_b32 v33, 0
    v_mov_b32 v34, 0
    v_mov_b32 v35, 0
    v_mov_b32 v36, 0
    v_mov_b32 v37, 0
    v_mov_b32 v38, 0
    v_mov_b32 v39, 0
    v_mov_b32 v40, 0
    v_mov_b32 v41, 0
    v_mov_b32 v42, 0
    v_mov_b32 v43, 0
    v_mov_b32 v44, 0
    v_mov_b32 v45, 0
    v_mov_b32 v46, 0
    v_mov_b32 v47, 0
    v_mov_b32 v48, 0
    v_mov_b32 v49, 0
    v_mov_b32 v50, 0
    v_mov_b32 v51, 0
    v_mov_b32 v52, 0
    v_mov_b32 v53, 0
    v_mov_b32 v54, 0
    v_mov_b32 v55, 0
    v_mov_b32 v56, 0
    v_mov_b32 v57, 0
    v_mov_b32 v58, 0
    v_mov_b32 v59, 0
    v_mov_b32 v60, 0
    v_mov_b32 v61, 0
    v_mov_b32 v62, 0
    v_mov_b32 v63, 0
    v_mov_b32 v64, 0
    v_mov_b32 v65, 0
    v_mov_b32 v66, 0
    v_mov_b32 v67, 0
    v_mov_b32 v68, 0
    v_mov_b32 v69, 0
    v_mov_b32 v70, 0
    v_mov_b32 v71, 0
    v_mov_b32 v72, 0
    v_mov_b32 v73, 0
    v_mov_b32 v74, 0
    v_mov_b32 v75, 0
    v_mov_b32 v76, 0
    v_mov_b32 v77, 0
    v_mov_b32 v78, 0
    v_mov_b32 v79, 0
    v_mov_b32 v80, 0
    v_mov_b32 v81, 0
    v_mov_b32 v82, 0
    v_mov_b32 v83, 0
    v_mov_b32 v84, 0
    v_mov_b32 v85, 0
    v_mov_b32 v86, 0
    v_mov_b32 v87, 0
    v_mov_b32 v88, 0
    v_mov_b32 v89, 0
    v_mov_b32 v90, 0
    v_mov_b32 v91, 0
    v_mov_b32 v92, 0
    v_mov_b32 v93, 0
    v_mov_b32 v94, 0
    v_mov_b32 v95, 0
    v_mov_b32 v96, 0
    v_mov_b32 v97, 0
    v_mov_b32 v98, 0
    v_mov_b32 v99, 0
    v_mov_b32 v100, 0
    v_mov_b32 v101, 0
    v_mov_b32 v102, 0
    v_mov_b32 v103, 0
    v_mov_b32 v104, 0
    v_mov_b32 v105, 0
    v_mov_b32 v106, 0
    v_mov_b32 v107, 0
    v_mov_b32 v108, 0
    v_mov_b32 v109, 0
    v_mov_b32 v110, 0
    v_mov_b32 v111, 0
    v_mov_b32 v112, 0
    v_mov_b32 v113, 0
    v_mov_b32 v114, 0
    v_mov_b32 v115, 0
    v_mov_b32 v116, 0
    v_mov_b32 v117, 0
    v_mov_b32 v118, 0
    v_mov_b32 v119, 0
    v_mov_b32 v120, 0
    v_mov_b32 v121, 0
    v_mov_b32 v122, 0
    v_mov_b32 v123, 0
    v_mov_b32 v124, 0
    v_mov_b32 v125, 0
    v_mov_b32 v126, 0
    v_mov_b32 v127, 0
    s_waitcnt lgkmcnt(0)
    s_mov_b32 s8, s4
    s_mov_b32 s9, s5
    s_mov_b32 s10, 2621440
    s_mov_b32 s11, 0x00020000
    s_mov_b32 s15, 0x00020000
    s_cmp_eq_u32 s36, 2
    s_cbranch_scc1 K1_srd_hc
    s_mov_b32 s12, s64
    s_mov_b32 s13, s65
    s_mov_b32 s14, 2457600
    s_branch K1_srd_dc
K1_srd_hc:
    s_mov_b32 s12, s24
    s_mov_b32 s13, s25
    s_mov_b32 s14, 1966080
K1_srd_dc:
    s_mov_b32 s16, s28
    s_mov_b32 s17, s29
    s_mov_b32 s18, 21836032
    s_mov_b32 s19, 0x00020000
    s_mov_b32 s92, s28
    s_mov_b32 s93, s29
    s_mov_b32 s94, 23068672
    s_mov_b32 s95, 0x00020000
    v_mov_b32 v9, 0x80000000
    v_mov_b32 v10, 0x80000000
    v_mov_b32 v11, 0x80000000
    v_mov_b32 v12, 0x80000000
    v_mov_b32 v13, 0x80000000
    v_mov_b32 v14, 0x80000000
    s_cmp_eq_u32 s36, 1
    s_cbranch_scc1 K1_main_v
    s_cmp_eq_u32 s36, 2
    s_cbranch_scc1 K1_pre_h
    s_lshl_b32 s43, s41, 2
    s_lshr_b32 s46, s40, 4
    s_add_u32 s43, s43, s46
    s_mul_i32 s43, s43, 768
    v_lshlrev_b32 v3, 3, v1
    v_add_u32 v3, s43, v3
    s_mov_b32 s49, 52429
    s_mov_b32 s52, 98304
    s_mov_b32 s53, 0x3ea52b5c
    s_add_u32 s46, s44, 0
    s_add_u32 s46, s46, s37
    s_cmp_lt_u32 s46, s62
    s_cselect_b32 s47, 0x80000000, 0
    s_lshl_b32 s46, s46, 2
    v_add_u32 v4, s46, v2
    v_mul_lo_u32 v5, v4, s49
    v_lshrrev_b32 v5, 18, v5
    v_mul_u32_u24 v6, 5, v5
    v_sub_u32 v6, v4, v6
    v_mul_lo_u32 v5, v5, s52
    v_lshl_add_u32 v5, v6, 7, v5
    v_add3_u32 v8, v5, v3, s47
    s_add_u32 s46, s44, 1
    s_add_u32 s46, s46, s37
    s_cmp_lt_u32 s46, s62
    s_cselect_b32 s47, 0x80000000, 0
    s_lshl_b32 s46, s46, 2
    v_add_u32 v4, s46, v2
    v_mul_lo_u32 v5, v4, s49
    v_lshrrev_b32 v5, 18, v5
    v_mul_u32_u24 v6, 5, v5
    v_sub_u32 v6, v4, v6
    v_mul_lo_u32 v5, v5, s52
    v_lshl_add_u32 v5, v6, 7, v5
    v_add3_u32 v9, v5, v3, s47
    s_add_u32 s46, s44, 2
    s_add_u32 s46, s46, s37
    s_cmp_lt_u32 s46, s62
    s_cselect_b32 s47, 0x80000000, 0
    s_lshl_b32 s46, s46, 2
    v_add_u32 v4, s46, v2
    v_mul_lo_u32 v5, v4, s49
    v_lshrrev_b32 v5, 18, v5
    v_mul_u32_u24 v6, 5, v5
    v_sub_u32 v6, v4, v6
    v_mul_lo_u32 v5, v5, s52
    v_lshl_add_u32 v5, v6, 7, v5
    v_add3_u32 v10, v5, v3, s47
    s_add_u32 s46, s44, 3
    s_add_u32 s46, s46, s37
    s_cmp_lt_u32 s46, s62
    s_cselect_b32 s47, 0x80000000, 0
    s_lshl_b32 s46, s46, 2
    v_add_u32 v4, s46, v2
    v_mul_lo_u32 v5, v4, s49
    v_lshrrev_b32 v5, 18, v5
    v_mul_u32_u24 v6, 5, v5
    v_sub_u32 v6, v4, v6
    v_mul_lo_u32 v5, v5, s52
    v_lshl_add_u32 v5, v6, 7, v5
    v_add3_u32 v11, v5, v3, s47
    s_add_u32 s46, s44, 4
    s_add_u32 s46, s46, s37
    s_cmp_lt_u32 s46, s62
    s_cselect_b32 s47, 0x80000000, 0
    s_lshl_b32 s46, s46, 2
    v_add_u32 v4, s46, v2
    v_mul_lo_u32 v5, v4, s49
    v_lshrrev_b32 v5, 18, v5
    v_mul_u32_u24 v6, 5, v5
    v_sub_u32 v6, v4, v6
    v_mul_lo_u32 v5, v5, s52
    v_lshl_add_u32 v5, v6, 7, v5
    v_add3_u32 v12, v5, v3, s47
    s_add_u32 s46, s44, 5
    s_add_u32 s46, s46, s37
    s_cmp_lt_u32 s46, s62
    s_cselect_b32 s47, 0x80000000, 0
    s_lshl_b32 s46, s46, 2
    v_add_u32 v4, s46, v2
    v_mul_lo_u32 v5, v4, s49
    v_lshrrev_b32 v5, 18, v5
    v_mul_u32_u24 v6, 5, v5
    v_sub_u32 v6, v4, v6
    v_mul_lo_u32 v5, v5, s52
    v_lshl_add_u32 v5, v6, 7, v5
    v_add3_u32 v13, v5, v3, s47
    s_mov_b32 s46, s45
    s_add_u32 s46, s46, s37
    s_cmp_lt_u32 s46, s62
    s_cselect_b32 s47, 0x80000000, 0
    s_lshl_b32 s46, s46, 2
    v_add_u32 v4, s46, v2
    v_mul_lo_u32 v5, v4, s49
    v_lshrrev_b32 v5, 18, v5
    v_mul_u32_u24 v6, 5, v5
    v_sub_u32 v6, v4, v6
    v_mul_lo_u32 v5, v5, s52
    v_lshl_add_u32 v5, v6, 7, v5
    v_add3_u32 v14, v5, v3, s47
    s_branch K1_pre_done
K1_pre_h:
    s_lshl_b32 s43, s33, 1
    s_add_u32 s43, s43, s41
    s_mul_i32 s43, s43, 196608
    s_add_u32 s43, s43, 9437184
    s_add_u32 s56, s37, s44
    s_lshl_b32 s56, s56, 11
    s_add_u32 s56, s56, s43
    v_and_b32 v4, 1, v2
    v_lshlrev_b32 v4, 1, v4
    v_lshrrev_b32 v5, 1, v2
    v_add_u32 v4, v4, v5
    v_lshl_add_u32 v4, v4, 4, v1
    v_lshlrev_b32 v4, 4, v4
    s_add_u32 s57, s37, 6
    s_lshl_b32 s57, s57, 11
    s_add_u32 s57, s57, s43
    s_lshl_b32 s48, s42, 1
    v_add_u32 v5, s48, v5
    v_lshl_add_u32 v5, v5, 4, v1
    v_lshlrev_b32 v5, 4, v5
    v_and_b32 v6, 1, v2
    v_lshl_add_u32 v5, v6, 10, v5
K1_pre_done:
    s_mov_b32 s46, 0
    s_mov_b32 s47, 0
    s_mov_b32 s50, 0xfffe8000
    s_mov_b32 s51, 49152
    s_barrier
    ds_read_b128 v[128:131], v216 offset:0
    ds_read_b128 v[132:135], v216 offset:2048
    ds_read_b128 v[136:139], v216 offset:4096
    ds_read_b128 v[140:143], v216 offset:6144
    ds_read_b64_tr_b16 v[144:145], v218 offset:0
    ds_read_b64_tr_b16 v[146:147], v218 offset:2048
    ds_read_b64_tr_b16 v[148:149], v219 offset:0
    ds_read_b64_tr_b16 v[150:151], v219 offset:2048
    ds_read_b64_tr_b16 v[152:153], v220 offset:0
    ds_read_b64_tr_b16 v[154:155], v220 offset:2048
    ds_read_b64_tr_b16 v[156:157], v221 offset:0
    ds_read_b64_tr_b16 v[158:159], v221 offset:2048
    ds_read_b64_tr_b16 v[160:161], v222 offset:0
    ds_read_b64_tr_b16 v[162:163], v222 offset:2048
    ds_read_b64_tr_b16 v[164:165], v223 offset:0
    ds_read_b64_tr_b16 v[166:167], v223 offset:2048
    ds_read_b64_tr_b16 v[168:169], v224 offset:0
    ds_read_b64_tr_b16 v[170:171], v224 offset:2048
K1_loop_s:
    s_add_u32 s47, s47, 1
    s_cmp_eq_u32 s47, 3
    s_cselect_b32 s48, s50, s51
    s_cselect_b32 s47, 0, s47
    s_waitcnt lgkmcnt(0)
    v_mfma_f32_16x16x32_bf16 v[16:19], v[144:147], v[128:131], v[16:19]
    ds_read_b128 v[172:175], v217 offset:0
    v_mfma_f32_16x16x32_bf16 v[20:23], v[144:147], v[132:135], v[20:23]
    ds_read_b128 v[176:179], v217 offset:2048
    v_mfma_f32_16x16x32_bf16 v[24:27], v[144:147], v[136:139], v[24:27]
    ds_read_b128 v[180:183], v217 offset:4096
    v_mfma_f32_16x16x32_bf16 v[28:31], v[144:147], v[140:143], v[28:31]
    ds_read_b128 v[184:187], v217 offset:6144
    v_mfma_f32_16x16x32_bf16 v[32:35], v[148:151], v[128:131], v[32:35]
    ds_read_b64_tr_b16 v[188:189], v218 offset:16384
    v_mfma_f32_16x16x32_bf16 v[36:39], v[148:151], v[132:135], v[36:39]
    ds_read_b64_tr_b16 v[190:191], v218 offset:18432
    v_mfma_f32_16x16x32_bf16 v[40:43], v[148:151], v[136:139], v[40:43]
    ds_read_b64_tr_b16 v[192:193], v219 offset:16384
    v_mfma_f32_16x16x32_bf16 v[44:47], v[148:151], v[140:143], v[44:47]
    ds_read_b64_tr_b16 v[194:195], v219 offset:18432
    v_mfma_f32_16x16x32_bf16 v[48:51], v[152:155], v[128:131], v[48:51]
    ds_read_b64_tr_b16 v[196:197], v220 offset:16384
    v_mfma_f32_16x16x32_bf16 v[52:55], v[152:155], v[132:135], v[52:55]
    ds_read_b64_tr_b16 v[198:199], v220 offset:18432
    v_mfma_f32_16x16x32_bf16 v[56:59], v[152:155], v[136:139], v[56:59]
    ds_read_b64_tr_b16 v[200:201], v221 offset:16384
    v_mfma_f32_16x16x32_bf16 v[60:63], v[152:155], v[140:143], v[60:63]
    ds_read_b64_tr_b16 v[202:203], v221 offset:18432
    v_mfma_f32_16x16x32_bf16 v[64:67], v[156:159], v[128:131], v[64:67]
    ds_read_b64_tr_b16 v[204:205], v222 offset:16384
    v_mfma_f32_16x16x32_bf16 v[68:71], v[156:159], v[132:135], v[68:71]
    ds_read_b64_tr_b16 v[206:207], v222 offset:18432
    v_mfma_f32_16x16x32_bf16 v[72:75], v[156:159], v[136:139], v[72:75]
    ds_read_b64_tr_b16 v[208:209], v223 offset:16384
    v_mfma_f32_16x16x32_bf16 v[76:79], v[156:159], v[140:143], v[76:79]
    ds_read_b64_tr_b16 v[210:211], v223 offset:18432
    v_mfma_f32_16x16x32_bf16 v[80:83], v[160:163], v[128:131], v[80:83]
    ds_read_b64_tr_b16 v[212:213], v224 offset:16384
    v_mfma_f32_16x16x32_bf16 v[84:87], v[160:163], v[132:135], v[84:87]
    ds_read_b64_tr_b16 v[214:215], v224 offset:18432
    v_mfma_f32_16x16x32_bf16 v[88:91], v[160:163], v[136:139], v[88:91]
    v_add_u32 v216, s48, v216
    v_mfma_f32_16x16x32_bf16 v[92:95], v[160:163], v[140:143], v[92:95]
    v_add_u32 v217, s48, v217
    v_mfma_f32_16x16x32_bf16 v[96:99], v[164:167], v[128:131], v[96:99]
    v_add_u32 v218, s48, v218
    v_mfma_f32_16x16x32_bf16 v[100:103], v[164:167], v[132:135], v[100:103]
    v_add_u32 v219, s48, v219
    v_mfma_f32_16x16x32_bf16 v[104:107], v[164:167], v[136:139], v[104:107]
    v_add_u32 v220, s48, v220
    v_mfma_f32_16x16x32_bf16 v[108:111], v[164:167], v[140:143], v[108:111]
    v_add_u32 v221, s48, v221
    v_mfma_f32_16x16x32_bf16 v[112:115], v[168:171], v[128:131], v[112:115]
    v_add_u32 v222, s48, v222
    v_mfma_f32_16x16x32_bf16 v[116:119], v[168:171], v[132:135], v[116:119]
    v_add_u32 v223, s48, v223
    v_mfma_f32_16x16x32_bf16 v[120:123], v[168:171], v[136:139], v[120:123]
    v_add_u32 v224, s48, v224
    v_mfma_f32_16x16x32_bf16 v[124:127], v[168:171], v[140:143], v[124:127]
    s_waitcnt lgkmcnt(0)
    s_barrier
    v_mfma_f32_16x16x32_bf16 v[16:19], v[188:191], v[172:175], v[16:19]
    ds_read_b128 v[128:131], v216 offset:0
    v_mfma_f32_16x16x32_bf16 v[20:23], v[188:191], v[176:179], v[20:23]
    ds_read_b128 v[132:135], v216 offset:2048
    v_mfma_f32_16x16x32_bf16 v[24:27], v[188:191], v[180:183], v[24:27]
    ds_read_b128 v[136:139], v216 offset:4096
    v_mfma_f32_16x16x32_bf16 v[28:31], v[188:191], v[184:187], v[28:31]
    ds_read_b128 v[140:143], v216 offset:6144
    v_mfma_f32_16x16x32_bf16 v[32:35], v[192:195], v[172:175], v[32:35]
    ds_read_b64_tr_b16 v[144:145], v218 offset:0
    v_mfma_f32_16x16x32_bf16 v[36:39], v[192:195], v[176:179], v[36:39]
    ds_read_b64_tr_b16 v[146:147], v218 offset:2048
    v_mfma_f32_16x16x32_bf16 v[40:43], v[192:195], v[180:183], v[40:43]
    ds_read_b64_tr_b16 v[148:149], v219 offset:0
    v_mfma_f32_16x16x32_bf16 v[44:47], v[192:195], v[184:187], v[44:47]
    ds_read_b64_tr_b16 v[150:151], v219 offset:2048
    v_mfma_f32_16x16x32_bf16 v[48:51], v[196:199], v[172:175], v[48:51]
    ds_read_b64_tr_b16 v[152:153], v220 offset:0
    v_mfma_f32_16x16x32_bf16 v[52:55], v[196:199], v[176:179], v[52:55]
    ds_read_b64_tr_b16 v[154:155], v220 offset:2048
    v_mfma_f32_16x16x32_bf16 v[56:59], v[196:199], v[180:183], v[56:59]
    ds_read_b64_tr_b16 v[156:157], v221 offset:0
    v_mfma_f32_16x16x32_bf16 v[60:63], v[196:199], v[184:187], v[60:63]
    ds_read_b64_tr_b16 v[158:159], v221 offset:2048
    v_mfma_f32_16x16x32_bf16 v[64:67], v[200:203], v[172:175], v[64:67]
    ds_read_b64_tr_b16 v[160:161], v222 offset:0
    v_mfma_f32_16x16x32_bf16 v[68:71], v[200:203], v[176:179], v[68:71]
    ds_read_b64_tr_b16 v[162:163], v222 offset:2048
    v_mfma_f32_16x16x32_bf16 v[72:75], v[200:203], v[180:183], v[72:75]
    ds_read_b64_tr_b16 v[164:165], v223 offset:0
    v_mfma_f32_16x16x32_bf16 v[76:79], v[200:203], v[184:187], v[76:79]
    ds_read_b64_tr_b16 v[166:167], v223 offset:2048
    v_mfma_f32_16x16x32_bf16 v[80:83], v[204:207], v[172:175], v[80:83]
    ds_read_b64_tr_b16 v[168:169], v224 offset:0
    v_mfma_f32_16x16x32_bf16 v[84:87], v[204:207], v[176:179], v[84:87]
    ds_read_b64_tr_b16 v[170:171], v224 offset:2048
    v_mfma_f32_16x16x32_bf16 v[88:91], v[204:207], v[180:183], v[88:91]
    s_add_u32 s46, s46, 1
    v_mfma_f32_16x16x32_bf16 v[92:95], v[204:207], v[184:187], v[92:95]
    s_cmp_lt_u32 s46, 10
    v_mfma_f32_16x16x32_bf16 v[96:99], v[208:211], v[172:175], v[96:99]
    v_mfma_f32_16x16x32_bf16 v[100:103], v[208:211], v[176:179], v[100:103]
    v_mfma_f32_16x16x32_bf16 v[104:107], v[208:211], v[180:183], v[104:107]
    v_mfma_f32_16x16x32_bf16 v[108:111], v[208:211], v[184:187], v[108:111]
    v_mfma_f32_16x16x32_bf16 v[112:115], v[212:215], v[172:175], v[112:115]
    v_mfma_f32_16x16x32_bf16 v[116:119], v[212:215], v[176:179], v[116:119]
    v_mfma_f32_16x16x32_bf16 v[120:123], v[212:215], v[180:183], v[120:123]
    v_mfma_f32_16x16x32_bf16 v[124:127], v[212:215], v[184:187], v[124:127]
    s_cbranch_scc1 K1_loop_s
    s_waitcnt lgkmcnt(0)
    s_nop 7
    s_cmp_eq_u32 s36, 2
    s_cbranch_scc1 K1_epi_h
    s_add_u32 s46, s44, 0
    s_add_u32 s46, s46, s37
    s_cmp_lt_u32 s46, 40
    s_cselect_b32 s54, s53, 1.0
    s_mov_b32 s55, s54
    v_pk_mul_f32 v[16:17], v[16:17], s[54:55]
    v_pk_mul_f32 v[18:19], v[18:19], s[54:55]
    v_cvt_pk_bf16_f32 v128, v16, v17
    v_cvt_pk_bf16_f32 v129, v18, v19
    buffer_store_dwordx2 v[128:129], v8, s[16:19], 0 offen offset:0 sc1
    v_pk_mul_f32 v[20:21], v[20:21], s[54:55]
    v_pk_mul_f32 v[22:23], v[22:23], s[54:55]
    v_cvt_pk_bf16_f32 v130, v20, v21
    v_cvt_pk_bf16_f32 v131, v22, v23
    buffer_store_dwordx2 v[130:131], v8, s[16:19], 0 offen offset:768 sc1
    v_pk_mul_f32 v[24:25], v[24:25], s[54:55]
    v_pk_mul_f32 v[26:27], v[26:27], s[54:55]
    v_cvt_pk_bf16_f32 v132, v24, v25
    v_cvt_pk_bf16_f32 v133, v26, v27
    buffer_store_dwordx2 v[132:133], v8, s[16:19], 0 offen offset:1536 sc1
    v_pk_mul_f32 v[28:29], v[28:29], s[54:55]
    v_pk_mul_f32 v[30:31], v[30:31], s[54:55]
    v_cvt_pk_bf16_f32 v134, v28, v29
    v_cvt_pk_bf16_f32 v135, v30, v31
    buffer_store_dwordx2 v[134:135], v8, s[16:19], 0 offen offset:2304 sc1
    s_add_u32 s46, s44, 1
    s_add_u32 s46, s46, s37
    s_cmp_lt_u32 s46, 40
    s_cselect_b32 s54, s53, 1.0
    s_mov_b32 s55, s54
    v_pk_mul_f32 v[32:33], v[32:33], s[54:55]
    v_pk_mul_f32 v[34:35], v[34:35], s[54:55]
    v_cvt_pk_bf16_f32 v136, v32, v33
    v_cvt_pk_bf16_f32 v137, v34, v35
    buffer_store_dwordx2 v[136:137], v9, s[16:19], 0 offen offset:0 sc1
    v_pk_mul_f32 v[36:37], v[36:37], s[54:55]
    v_pk_mul_f32 v[38:39], v[38:39], s[54:55]
    v_cvt_pk_bf16_f32 v138, v36, v37
    v_cvt_pk_bf16_f32 v139, v38, v39
    buffer_store_dwordx2 v[138:139], v9, s[16:19], 0 offen offset:768 sc1
    v_pk_mul_f32 v[40:41], v[40:41], s[54:55]
    v_pk_mul_f32 v[42:43], v[42:43], s[54:55]
    v_cvt_pk_bf16_f32 v140, v40, v41
    v_cvt_pk_bf16_f32 v141, v42, v43
    buffer_store_dwordx2 v[140:141], v9, s[16:19], 0 offen offset:1536 sc1
    v_pk_mul_f32 v[44:45], v[44:45], s[54:55]
    v_pk_mul_f32 v[46:47], v[46:47], s[54:55]
    v_cvt_pk_bf16_f32 v142, v44, v45
    v_cvt_pk_bf16_f32 v143, v46, v47
    buffer_store_dwordx2 v[142:143], v9, s[16:19], 0 offen offset:2304 sc1
    s_add_u32 s46, s44, 2
    s_add_u32 s46, s46, s37
    s_cmp_lt_u32 s46, 40
    s_cselect_b32 s54, s53, 1.0
    s_mov_b32 s55, s54
    v_pk_mul_f32 v[48:49], v[48:49], s[54:55]
    v_pk_mul_f32 v[50:51], v[50:51], s[54:55]
    v_cvt_pk_bf16_f32 v144, v48, v49
    v_cvt_pk_bf16_f32 v145, v50, v51
    buffer_store_dwordx2 v[144:145], v10, s[16:19], 0 offen offset:0 sc1
    v_pk_mul_f32 v[52:53], v[52:53], s[54:55]
    v_pk_mul_f32 v[54:55], v[54:55], s[54:55]
    v_cvt_pk_bf16_f32 v146, v52, v53
    v_cvt_pk_bf16_f32 v147, v54, v55
    buffer_store_dwordx2 v[146:147], v10, s[16:19], 0 offen offset:768 sc1
    v_pk_mul_f32 v[56:57], v[56:57], s[54:55]
    v_pk_mul_f32 v[58:59], v[58:59], s[54:55]
    v_cvt_pk_bf16_f32 v148, v56, v57
    v_cvt_pk_bf16_f32 v149, v58, v59
    buffer_store_dwordx2 v[148:149], v10, s[16:19], 0 offen offset:1536 sc1
    v_pk_mul_f32 v[60:61], v[60:61], s[54:55]
    v_pk_mul_f32 v[62:63], v[62:63], s[54:55]
    v_cvt_pk_bf16_f32 v150, v60, v61
    v_cvt_pk_bf16_f32 v151, v62, v63
    buffer_store_dwordx2 v[150:151], v10, s[16:19], 0 offen offset:2304 sc1
    s_add_u32 s46, s44, 3
    s_add_u32 s46, s46, s37
    s_cmp_lt_u32 s46, 40
    s_cselect_b32 s54, s53, 1.0
    s_mov_b32 s55, s54
    v_pk_mul_f32 v[64:65], v[64:65], s[54:55]
    v_pk_mul_f32 v[66:67], v[66:67], s[54:55]
    v_cvt_pk_bf16_f32 v152, v64, v65
    v_cvt_pk_bf16_f32 v153, v66, v67
    buffer_store_dwordx2 v[152:153], v11, s[16:19], 0 offen offset:0 sc1
    v_pk_mul_f32 v[68:69], v[68:69], s[54:55]
    v_pk_mul_f32 v[70:71], v[70:71], s[54:55]
    v_cvt_pk_bf16_f32 v154, v68, v69
    v_cvt_pk_bf16_f32 v155, v70, v71
    buffer_store_dwordx2 v[154:155], v11, s[16:19], 0 offen offset:768 sc1
    v_pk_mul_f32 v[72:73], v[72:73], s[54:55]
    v_pk_mul_f32 v[74:75], v[74:75], s[54:55]
    v_cvt_pk_bf16_f32 v156, v72, v73
    v_cvt_pk_bf16_f32 v157, v74, v75
    buffer_store_dwordx2 v[156:157], v11, s[16:19], 0 offen offset:1536 sc1
    v_pk_mul_f32 v[76:77], v[76:77], s[54:55]
    v_pk_mul_f32 v[78:79], v[78:79], s[54:55]
    v_cvt_pk_bf16_f32 v158, v76, v77
    v_cvt_pk_bf16_f32 v159, v78, v79
    buffer_store_dwordx2 v[158:159], v11, s[16:19], 0 offen offset:2304 sc1
    s_add_u32 s46, s44, 4
    s_add_u32 s46, s46, s37
    s_cmp_lt_u32 s46, 40
    s_cselect_b32 s54, s53, 1.0
    s_mov_b32 s55, s54
    v_pk_mul_f32 v[80:81], v[80:81], s[54:55]
    v_pk_mul_f32 v[82:83], v[82:83], s[54:55]
    v_cvt_pk_bf16_f32 v160, v80, v81
    v_cvt_pk_bf16_f32 v161, v82, v83
    buffer_store_dwordx2 v[160:161], v12, s[16:19], 0 offen offset:0 sc1
    v_pk_mul_f32 v[84:85], v[84:85], s[54:55]
    v_pk_mul_f32 v[86:87], v[86:87], s[54:55]
    v_cvt_pk_bf16_f32 v162, v84, v85
    v_cvt_pk_bf16_f32 v163, v86, v87
    buffer_store_dwordx2 v[162:163], v12, s[16:19], 0 offen offset:768 sc1
    v_pk_mul_f32 v[88:89], v[88:89], s[54:55]
    v_pk_mul_f32 v[90:91], v[90:91], s[54:55]
    v_cvt_pk_bf16_f32 v164, v88, v89
    v_cvt_pk_bf16_f32 v165, v90, v91
    buffer_store_dwordx2 v[164:165], v12, s[16:19], 0 offen offset:1536 sc1
    v_pk_mul_f32 v[92:93], v[92:93], s[54:55]
    v_pk_mul_f32 v[94:95], v[94:95], s[54:55]
    v_cvt_pk_bf16_f32 v166, v92, v93
    v_cvt_pk_bf16_f32 v167, v94, v95
    buffer_store_dwordx2 v[166:167], v12, s[16:19], 0 offen offset:2304 sc1
    s_add_u32 s46, s44, 5
    s_add_u32 s46, s46, s37
    s_cmp_lt_u32 s46, 40
    s_cselect_b32 s54, s53, 1.0
    s_mov_b32 s55, s54
    v_pk_mul_f32 v[96:97], v[96:97], s[54:55]
    v_pk_mul_f32 v[98:99], v[98:99], s[54:55]
    v_cvt_pk_bf16_f32 v168, v96, v97
    v_cvt_pk_bf16_f32 v169, v98, v99
    buffer_store_dwordx2 v[168:169], v13, s[16:19], 0 offen offset:0 sc1
    v_pk_mul_f32 v[100:101], v[100:101], s[54:55]
    v_pk_mul_f32 v[102:103], v[102:103], s[54:55]
    v_cvt_pk_bf16_f32 v170, v100, v101
    v_cvt_pk_bf16_f32 v171, v102, v103
    buffer_store_dwordx2 v[170:171], v13, s[16:19], 0 offen offset:768 sc1
    v_pk_mul_f32 v[104:105], v[104:105], s[54:55]
    v_pk_mul_f32 v[106:107], v[106:107], s[54:55]
    v_cvt_pk_bf16_f32 v172, v104, v105
    v_cvt_pk_bf16_f32 v173, v106, v107
    buffer_store_dwordx2 v[172:173], v13, s[16:19], 0 offen offset:1536 sc1
    v_pk_mul_f32 v[108:109], v[108:109], s[54:55]
    v_pk_mul_f32 v[110:111], v[110:111], s[54:55]
    v_cvt_pk_bf16_f32 v174, v108, v109
    v_cvt_pk_bf16_f32 v175, v110, v111
    buffer_store_dwordx2 v[174:175], v13, s[16:19], 0 offen offset:2304 sc1
    s_mov_b32 s46, s45
    s_add_u32 s46, s46, s37
    s_cmp_lt_u32 s46, 40
    s_cselect_b32 s54, s53, 1.0
    s_mov_b32 s55, s54
    v_pk_mul_f32 v[112:113], v[112:113], s[54:55]
    v_pk_mul_f32 v[114:115], v[114:115], s[54:55]
    v_cvt_pk_bf16_f32 v176, v112, v113
    v_cvt_pk_bf16_f32 v177, v114, v115
    buffer_store_dwordx2 v[176:177], v14, s[16:19], 0 offen offset:0 sc1
    v_pk_mul_f32 v[116:117], v[116:117], s[54:55]
    v_pk_mul_f32 v[118:119], v[118:119], s[54:55]
    v_cvt_pk_bf16_f32 v178, v116, v117
    v_cvt_pk_bf16_f32 v179, v118, v119
    buffer_store_dwordx2 v[178:179], v14, s[16:19], 0 offen offset:768 sc1
    v_pk_mul_f32 v[120:121], v[120:121], s[54:55]
    v_pk_mul_f32 v[122:123], v[122:123], s[54:55]
    v_cvt_pk_bf16_f32 v180, v120, v121
    v_cvt_pk_bf16_f32 v181, v122, v123
    buffer_store_dwordx2 v[180:181], v14, s[16:19], 0 offen offset:1536 sc1
    v_pk_mul_f32 v[124:125], v[124:125], s[54:55]
    v_pk_mul_f32 v[126:127], v[126:127], s[54:55]
    v_cvt_pk_bf16_f32 v182, v124, v125
    v_cvt_pk_bf16_f32 v183, v126, v127
    buffer_store_dwordx2 v[182:183], v14, s[16:19], 0 offen offset:2304 sc1
    s_branch KF_p1done
K1_epi_h:
    s_add_u32 s49, s56, 0
    s_add_u32 s46, s37, s44
    s_add_u32 s46, s46, 0
    s_cmp_lt_u32 s46, s62
    s_cselect_b32 s49, 0x7f000000, s49
    v_cvt_pk_bf16_f32 v128, v16, v17
    v_cvt_pk_bf16_f32 v129, v18, v19
    v_cvt_pk_bf16_f32 v130, v32, v33
    v_cvt_pk_bf16_f32 v131, v34, v35
    v_pk_max_i16 v128, v128, 0
    v_pk_max_i16 v129, v129, 0
    v_pk_max_i16 v130, v130, 0
    v_pk_max_i16 v131, v131, 0
    s_nop 0
    v_permlane16_swap_b32 v128, v130
    v_permlane16_swap_b32 v129, v131
    buffer_store_dwordx4 v[128:131], v4, s[16:19], s49 offen offset:0 sc1
    v_cvt_pk_bf16_f32 v132, v20, v21
    v_cvt_pk_bf16_f32 v133, v22, v23
    v_cvt_pk_bf16_f32 v134, v36, v37
    v_cvt_pk_bf16_f32 v135, v38, v39
    v_pk_max_i16 v132, v132, 0
    v_pk_max_i16 v133, v133, 0
    v_pk_max_i16 v134, v134, 0
    v_pk_max_i16 v135, v135, 0
    s_nop 0
    v_permlane16_swap_b32 v132, v134
    v_permlane16_swap_b32 v133, v135
    buffer_store_dwordx4 v[132:135], v4, s[16:19], s49 offen offset:1024 sc1
    v_cvt_pk_bf16_f32 v136, v24, v25
    v_cvt_pk_bf16_f32 v137, v26, v27
    v_cvt_pk_bf16_f32 v138, v40, v41
    v_cvt_pk_bf16_f32 v139, v42, v43
    v_pk_max_i16 v136, v136, 0
    v_pk_max_i16 v137, v137, 0
    v_pk_max_i16 v138, v138, 0
    v_pk_max_i16 v139, v139, 0
    s_nop 0
    v_permlane16_swap_b32 v136, v138
    v_permlane16_swap_b32 v137, v139
    buffer_store_dwordx4 v[136:139], v4, s[16:19], s49 offen offset:2048 sc1
    v_cvt_pk_bf16_f32 v140, v28, v29
    v_cvt_pk_bf16_f32 v141, v30, v31
    v_cvt_pk_bf16_f32 v142, v44, v45
    v_cvt_pk_bf16_f32 v143, v46, v47
    v_pk_max_i16 v140, v140, 0
    v_pk_max_i16 v141, v141, 0
    v_pk_max_i16 v142, v142, 0
    v_pk_max_i16 v143, v143, 0
    s_nop 0
    v_permlane16_swap_b32 v140, v142
    v_permlane16_swap_b32 v141, v143
    buffer_store_dwordx4 v[140:143], v4, s[16:19], s49 offen offset:3072 sc1
    s_add_u32 s49, s56, 4096
    s_add_u32 s46, s37, s44
    s_add_u32 s46, s46, 2
    s_cmp_lt_u32 s46, s62
    s_cselect_b32 s49, 0x7f000000, s49
    v_cvt_pk_bf16_f32 v144, v48, v49
    v_cvt_pk_bf16_f32 v145, v50, v51
    v_cvt_pk_bf16_f32 v146, v64, v65
    v_cvt_pk_bf16_f32 v147, v66, v67
    v_pk_max_i16 v144, v144, 0
    v_pk_max_i16 v145, v145, 0
    v_pk_max_i16 v146, v146, 0
    v_pk_max_i16 v147, v147, 0
    s_nop 0
    v_permlane16_swap_b32 v144, v146
    v_permlane16_swap_b32 v145, v147
    buffer_store_dwordx4 v[144:147], v4, s[16:19], s49 offen offset:0 sc1
    v_cvt_pk_bf16_f32 v148, v52, v53
    v_cvt_pk_bf16_f32 v149, v54, v55
    v_cvt_pk_bf16_f32 v150, v68, v69
    v_cvt_pk_bf16_f32 v151, v70, v71
    v_pk_max_i16 v148, v148, 0
    v_pk_max_i16 v149, v149, 0
    v_pk_max_i16 v150, v150, 0
    v_pk_max_i16 v151, v151, 0
    s_nop 0
    v_permlane16_swap_b32 v148, v150
    v_permlane16_swap_b32 v149, v151
    buffer_store_dwordx4 v[148:151], v4, s[16:19], s49 offen offset:1024 sc1
    v_cvt_pk_bf16_f32 v152, v56, v57
    v_cvt_pk_bf16_f32 v153, v58, v59
    v_cvt_pk_bf16_f32 v154, v72, v73
    v_cvt_pk_bf16_f32 v155, v74, v75
    v_pk_max_i16 v152, v152, 0
    v_pk_max_i16 v153, v153, 0
    v_pk_max_i16 v154, v154, 0
    v_pk_max_i16 v155, v155, 0
    s_nop 0
    v_permlane16_swap_b32 v152, v154
    v_permlane16_swap_b32 v153, v155
    buffer_store_dwordx4 v[152:155], v4, s[16:19], s49 offen offset:2048 sc1
    v_cvt_pk_bf16_f32 v156, v60, v61
    v_cvt_pk_bf16_f32 v157, v62, v63
    v_cvt_pk_bf16_f32 v158, v76, v77
    v_cvt_pk_bf16_f32 v159, v78, v79
    v_pk_max_i16 v156, v156, 0
    v_pk_max_i16 v157, v157, 0
    v_pk_max_i16 v158, v158, 0
    v_pk_max_i16 v159, v159, 0
    s_nop 0
    v_permlane16_swap_b32 v156, v158
    v_permlane16_swap_b32 v157, v159
    buffer_store_dwordx4 v[156:159], v4, s[16:19], s49 offen offset:3072 sc1
    s_add_u32 s49, s56, 8192
    s_add_u32 s46, s37, s44
    s_add_u32 s46, s46, 4
    s_cmp_lt_u32 s46, s62
    s_cselect_b32 s49, 0x7f000000, s49
    v_cvt_pk_bf16_f32 v160, v80, v81
    v_cvt_pk_bf16_f32 v161, v82, v83
    v_cvt_pk_bf16_f32 v162, v96, v97
    v_cvt_pk_bf16_f32 v163, v98, v99
    v_pk_max_i16 v160, v160, 0
    v_pk_max_i16 v161, v161, 0
    v_pk_max_i16 v162, v162, 0
    v_pk_max_i16 v163, v163, 0
    s_nop 0
    v_permlane16_swap_b32 v160, v162
    v_permlane16_swap_b32 v161, v163
    buffer_store_dwordx4 v[160:163], v4, s[16:19], s49 offen offset:0 sc1
    v_cvt_pk_bf16_f32 v164, v84, v85
    v_cvt_pk_bf16_f32 v165, v86, v87
    v_cvt_pk_bf16_f32 v166, v100, v101
    v_cvt_pk_bf16_f32 v167, v102, v103
    v_pk_max_i16 v164, v164, 0
    v_pk_max_i16 v165, v165, 0
    v_pk_max_i16 v166, v166, 0
    v_pk_max_i16 v167, v167, 0
    s_nop 0
    v_permlane16_swap_b32 v164, v166
    v_permlane16_swap_b32 v165, v167
    buffer_store_dwordx4 v[164:167], v4, s[16:19], s49 offen offset:1024 sc1
    v_cvt_pk_bf16_f32 v168, v88, v89
    v_cvt_pk_bf16_f32 v169, v90, v91
    v_cvt_pk_bf16_f32 v170, v104, v105
    v_cvt_pk_bf16_f32 v171, v106, v107
    v_pk_max_i16 v168, v168, 0
    v_pk_max_i16 v169, v169, 0
    v_pk_max_i16 v170, v170, 0
    v_pk_max_i16 v171, v171, 0
    s_nop 0
    v_permlane16_swap_b32 v168, v170
    v_permlane16_swap_b32 v169, v171
    buffer_store_dwordx4 v[168:171], v4, s[16:19], s49 offen offset:2048 sc1
    v_cvt_pk_bf16_f32 v172, v92, v93
    v_cvt_pk_bf16_f32 v173, v94, v95
    v_cvt_pk_bf16_f32 v174, v108, v109
    v_cvt_pk_bf16_f32 v175, v110, v111
    v_pk_max_i16 v172, v172, 0
    v_pk_max_i16 v173, v173, 0
    v_pk_max_i16 v174, v174, 0
    v_pk_max_i16 v175, v175, 0
    s_nop 0
    v_permlane16_swap_b32 v172, v174
    v_permlane16_swap_b32 v173, v175
    buffer_store_dwordx4 v[172:175], v4, s[16:19], s49 offen offset:3072 sc1
    v_cvt_pk_bf16_f32 v176, v112, v113
    v_cvt_pk_bf16_f32 v177, v114, v115
    v_cvt_pk_bf16_f32 v178, v116, v117
    v_cvt_pk_bf16_f32 v179, v118, v119
    v_pk_max_i16 v176, v176, 0
    v_pk_max_i16 v177, v177, 0
    v_pk_max_i16 v178, v178, 0
    v_pk_max_i16 v179, v179, 0
    s_nop 0
    v_permlane16_swap_b32 v176, v178
    v_permlane16_swap_b32 v177, v179
    buffer_store_dwordx4 v[176:179], v5, s[16:19], s57 offen offset:0 sc1
    v_cvt_pk_bf16_f32 v180, v120, v121
    v_cvt_pk_bf16_f32 v181, v122, v123
    v_cvt_pk_bf16_f32 v182, v124, v125
    v_cvt_pk_bf16_f32 v183, v126, v127
    v_pk_max_i16 v180, v180, 0
    v_pk_max_i16 v181, v181, 0
    v_pk_max_i16 v182, v182, 0
    v_pk_max_i16 v183, v183, 0
    s_nop 0
    v_permlane16_swap_b32 v180, v182
    v_permlane16_swap_b32 v181, v183
    buffer_store_dwordx4 v[180:183], v5, s[16:19], s57 offen offset:2048 sc1
    s_branch KF_p1done
K1_main_v:
    s_lshl_b32 s43, s41, 1
    s_lshr_b32 s46, s40, 5
    s_add_u32 s43, s43, s46
    s_lshl_b32 s43, s43, 10
    s_add_u32 s43, s43, 6291456
    v_lshlrev_b32 v3, 4, v0
    v_add_u32 v3, s43, v3
    s_add_u32 s46, s44, 0
    s_add_u32 s46, s46, s37
    s_cmp_lt_u32 s46, s62
    s_cselect_b32 s47, 0x80000000, 0
    s_lshl_b32 s46, s46, 16
    s_or_b32 s46, s46, s47
    v_add_u32 v8, s46, v3
    s_add_u32 s46, s44, 1
    s_add_u32 s46, s46, s37
    s_cmp_lt_u32 s46, s62
    s_cselect_b32 s47, 0x80000000, 0
    s_lshl_b32 s46, s46, 16
    s_or_b32 s46, s46, s47
    v_add_u32 v9, s46, v3
    s_add_u32 s46, s44, 2
    s_add_u32 s46, s46, s37
    s_cmp_lt_u32 s46, s62
    s_cselect_b32 s47, 0x80000000, 0
    s_lshl_b32 s46, s46, 16
    s_or_b32 s46, s46, s47
    v_add_u32 v10, s46, v3
    s_add_u32 s46, s44, 3
    s_add_u32 s46, s46, s37
    s_cmp_lt_u32 s46, s62
    s_cselect_b32 s47, 0x80000000, 0
    s_lshl_b32 s46, s46, 16
    s_or_b32 s46, s46, s47
    v_add_u32 v11, s46, v3
    s_add_u32 s46, s44, 4
    s_add_u32 s46, s46, s37
    s_cmp_lt_u32 s46, s62
    s_cselect_b32 s47, 0x80000000, 0
    s_lshl_b32 s46, s46, 16
    s_or_b32 s46, s46, s47
    v_add_u32 v12, s46, v3
    s_add_u32 s46, s44, 5
    s_add_u32 s46, s46, s37
    s_cmp_lt_u32 s46, s62
    s_cselect_b32 s47, 0x80000000, 0
    s_lshl_b32 s46, s46, 16
    s_or_b32 s46, s46, s47
    v_add_u32 v13, s46, v3
    s_mov_b32 s46, s45
    s_add_u32 s46, s46, s37
    s_cmp_lt_u32 s46, s62
    s_cselect_b32 s47, 0x80000000, 0
    s_lshl_b32 s46, s46, 16
    s_or_b32 s46, s46, s47
    v_add_u32 v14, s46, v3
    s_mov_b32 s46, 0
    s_mov_b32 s47, 0
    s_mov_b32 s50, 0xfffe8000
    s_mov_b32 s51, 49152
    s_barrier
    ds_read_b128 v[128:131], v216 offset:0
    ds_read_b128 v[132:135], v216 offset:2048
    ds_read_b128 v[136:139], v216 offset:4096
    ds_read_b128 v[140:143], v216 offset:6144
    ds_read_b64_tr_b16 v[144:145], v218 offset:0
    ds_read_b64_tr_b16 v[146:147], v218 offset:2048
    ds_read_b64_tr_b16 v[148:149], v219 offset:0
    ds_read_b64_tr_b16 v[150:151], v219 offset:2048
    ds_read_b64_tr_b16 v[152:153], v220 offset:0
    ds_read_b64_tr_b16 v[154:155], v220 offset:2048
    ds_read_b64_tr_b16 v[156:157], v221 offset:0
    ds_read_b64_tr_b16 v[158:159], v221 offset:2048
    ds_read_b64_tr_b16 v[160:161], v222 offset:0
    ds_read_b64_tr_b16 v[162:163], v222 offset:2048
    ds_read_b64_tr_b16 v[164:165], v223 offset:0
    ds_read_b64_tr_b16 v[166:167], v223 offset:2048
    ds_read_b64_tr_b16 v[168:169], v224 offset:0
    ds_read_b64_tr_b16 v[170:171], v224 offset:2048
K1_loop_n:
    s_add_u32 s47, s47, 1
    s_cmp_eq_u32 s47, 3
    s_cselect_b32 s48, s50, s51
    s_cselect_b32 s47, 0, s47
    s_waitcnt lgkmcnt(0)
    v_mfma_f32_16x16x32_bf16 v[16:19], v[128:131], v[144:147], v[16:19]
    ds_read_b128 v[172:175], v217 offset:0
    v_mfma_f32_16x16x32_bf16 v[20:23], v[132:135], v[144:147], v[20:23]
    ds_read_b128 v[176:179], v217 offset:2048
    v_mfma_f32_16x16x32_bf16 v[24:27], v[136:139], v[144:147], v[24:27]
    ds_read_b128 v[180:183], v217 offset:4096
    v_mfma_f32_16x16x32_bf16 v[28:31], v[140:143], v[144:147], v[28:31]
    ds_read_b128 v[184:187], v217 offset:6144
    v_mfma_f32_16x16x32_bf16 v[32:35], v[128:131], v[148:151], v[32:35]
    ds_read_b64_tr_b16 v[188:189], v218 offset:16384
    v_mfma_f32_16x16x32_bf16 v[36:39], v[132:135], v[148:151], v[36:39]
    ds_read_b64_tr_b16 v[190:191], v218 offset:18432
    v_mfma_f32_16x16x32_bf16 v[40:43], v[136:139], v[148:151], v[40:43]
    ds_read_b64_tr_b16 v[192:193], v219 offset:16384
    v_mfma_f32_16x16x32_bf16 v[44:47], v[140:143], v[148:151], v[44:47]
    ds_read_b64_tr_b16 v[194:195], v219 offset:18432
    v_mfma_f32_16x16x32_bf16 v[48:51], v[128:131], v[152:155], v[48:51]
    ds_read_b64_tr_b16 v[196:197], v220 offset:16384
    v_mfma_f32_16x16x32_bf16 v[52:55], v[132:135], v[152:155], v[52:55]
    ds_read_b64_tr_b16 v[198:199], v220 offset:18432
    v_mfma_f32_16x16x32_bf16 v[56:59], v[136:139], v[152:155], v[56:59]
    ds_read_b64_tr_b16 v[200:201], v221 offset:16384
    v_mfma_f32_16x16x32_bf16 v[60:63], v[140:143], v[152:155], v[60:63]
    ds_read_b64_tr_b16 v[202:203], v221 offset:18432
    v_mfma_f32_16x16x32_bf16 v[64:67], v[128:131], v[156:159], v[64:67]
    ds_read_b64_tr_b16 v[204:205], v222 offset:16384
    v_mfma_f32_16x16x32_bf16 v[68:71], v[132:135], v[156:159], v[68:71]
    ds_read_b64_tr_b16 v[206:207], v222 offset:18432
    v_mfma_f32_16x16x32_bf16 v[72:75], v[136:139], v[156:159], v[72:75]
    ds_read_b64_tr_b16 v[208:209], v223 offset:16384
    v_mfma_f32_16x16x32_bf16 v[76:79], v[140:143], v[156:159], v[76:79]
    ds_read_b64_tr_b16 v[210:211], v223 offset:18432
    v_mfma_f32_16x16x32_bf16 v[80:83], v[128:131], v[160:163], v[80:83]
    ds_read_b64_tr_b16 v[212:213], v224 offset:16384
    v_mfma_f32_16x16x32_bf16 v[84:87], v[132:135], v[160:163], v[84:87]
    ds_read_b64_tr_b16 v[214:215], v224 offset:18432
    v_mfma_f32_16x16x32_bf16 v[88:91], v[136:139], v[160:163], v[88:91]
    v_add_u32 v216, s48, v216
    v_mfma_f32_16x16x32_bf16 v[92:95], v[140:143], v[160:163], v[92:95]
    v_add_u32 v217, s48, v217
    v_mfma_f32_16x16x32_bf16 v[96:99], v[128:131], v[164:167], v[96:99]
    v_add_u32 v218, s48, v218
    v_mfma_f32_16x16x32_bf16 v[100:103], v[132:135], v[164:167], v[100:103]
    v_add_u32 v219, s48, v219
    v_mfma_f32_16x16x32_bf16 v[104:107], v[136:139], v[164:167], v[104:107]
    v_add_u32 v220, s48, v220
    v_mfma_f32_16x16x32_bf16 v[108:111], v[140:143], v[164:167], v[108:111]
    v_add_u32 v221, s48, v221
    v_mfma_f32_16x16x32_bf16 v[112:115], v[128:131], v[168:171], v[112:115]
    v_add_u32 v222, s48, v222
    v_mfma_f32_16x16x32_bf16 v[116:119], v[132:135], v[168:171], v[116:119]
    v_add_u32 v223, s48, v223
    v_mfma_f32_16x16x32_bf16 v[120:123], v[136:139], v[168:171], v[120:123]
    v_add_u32 v224, s48, v224
    v_mfma_f32_16x16x32_bf16 v[124:127], v[140:143], v[168:171], v[124:127]
    s_waitcnt lgkmcnt(0)
    s_barrier
    v_mfma_f32_16x16x32_bf16 v[16:19], v[172:175], v[188:191], v[16:19]
    ds_read_b128 v[128:131], v216 offset:0
    v_mfma_f32_16x16x32_bf16 v[20:23], v[176:179], v[188:191], v[20:23]
    ds_read_b128 v[132:135], v216 offset:2048
    v_mfma_f32_16x16x32_bf16 v[24:27], v[180:183], v[188:191], v[24:27]
    ds_read_b128 v[136:139], v216 offset:4096
    v_mfma_f32_16x16x32_bf16 v[28:31], v[184:187], v[188:191], v[28:31]
    ds_read_b128 v[140:143], v216 offset:6144
    v_mfma_f32_16x16x32_bf16 v[32:35], v[172:175], v[192:195], v[32:35]
    ds_read_b64_tr_b16 v[144:145], v218 offset:0
    v_mfma_f32_16x16x32_bf16 v[36:39], v[176:179], v[192:195], v[36:39]
    ds_read_b64_tr_b16 v[146:147], v218 offset:2048
    v_mfma_f32_16x16x32_bf16 v[40:43], v[180:183], v[192:195], v[40:43]
    ds_read_b64_tr_b16 v[148:149], v219 offset:0
    v_mfma_f32_16x16x32_bf16 v[44:47], v[184:187], v[192:195], v[44:47]
    ds_read_b64_tr_b16 v[150:151], v219 offset:2048
    v_mfma_f32_16x16x32_bf16 v[48:51], v[172:175], v[196:199], v[48:51]
    ds_read_b64_tr_b16 v[152:153], v220 offset:0
    v_mfma_f32_16x16x32_bf16 v[52:55], v[176:179], v[196:199], v[52:55]
    ds_read_b64_tr_b16 v[154:155], v220 offset:2048
    v_mfma_f32_16x16x32_bf16 v[56:59], v[180:183], v[196:199], v[56:59]
    ds_read_b64_tr_b16 v[156:157], v221 offset:0
    v_mfma_f32_16x16x32_bf16 v[60:63], v[184:187], v[196:199], v[60:63]
    ds_read_b64_tr_b16 v[158:159], v221 offset:2048
    v_mfma_f32_16x16x32_bf16 v[64:67], v[172:175], v[200:203], v[64:67]
    ds_read_b64_tr_b16 v[160:161], v222 offset:0
    v_mfma_f32_16x16x32_bf16 v[68:71], v[176:179], v[200:203], v[68:71]
    ds_read_b64_tr_b16 v[162:163], v222 offset:2048
    v_mfma_f32_16x16x32_bf16 v[72:75], v[180:183], v[200:203], v[72:75]
    ds_read_b64_tr_b16 v[164:165], v223 offset:0
    v_mfma_f32_16x16x32_bf16 v[76:79], v[184:187], v[200:203], v[76:79]
    ds_read_b64_tr_b16 v[166:167], v223 offset:2048
    v_mfma_f32_16x16x32_bf16 v[80:83], v[172:175], v[204:207], v[80:83]
    ds_read_b64_tr_b16 v[168:169], v224 offset:0
    v_mfma_f32_16x16x32_bf16 v[84:87], v[176:179], v[204:207], v[84:87]
    ds_read_b64_tr_b16 v[170:171], v224 offset:2048
    v_mfma_f32_16x16x32_bf16 v[88:91], v[180:183], v[204:207], v[88:91]
    s_add_u32 s46, s46, 1
    v_mfma_f32_16x16x32_bf16 v[92:95], v[184:187], v[204:207], v[92:95]
    s_cmp_lt_u32 s46, 10
    v_mfma_f32_16x16x32_bf16 v[96:99], v[172:175], v[208:211], v[96:99]
    v_mfma_f32_16x16x32_bf16 v[100:103], v[176:179], v[208:211], v[100:103]
    v_mfma_f32_16x16x32_bf16 v[104:107], v[180:183], v[208:211], v[104:107]
    v_mfma_f32_16x16x32_bf16 v[108:111], v[184:187], v[208:211], v[108:111]
    v_mfma_f32_16x16x32_bf16 v[112:115], v[172:175], v[212:215], v[112:115]
    v_mfma_f32_16x16x32_bf16 v[116:119], v[176:179], v[212:215], v[116:119]
    v_mfma_f32_16x16x32_bf16 v[120:123], v[180:183], v[212:215], v[120:123]
    v_mfma_f32_16x16x32_bf16 v[124:127], v[184:187], v[212:215], v[124:127]
    s_cbranch_scc1 K1_loop_n
    s_waitcnt lgkmcnt(0)
    s_nop 7
    v_cvt_pk_bf16_f32 v128, v16, v17
    v_cvt_pk_bf16_f32 v129, v18, v19
    v_cvt_pk_bf16_f32 v130, v20, v21
    v_cvt_pk_bf16_f32 v131, v22, v23
    buffer_store_dwordx4 v[128:131], v8, s[16:19], 0 offen offset:0 sc1
    v_cvt_pk_bf16_f32 v132, v24, v25
    v_cvt_pk_bf16_f32 v133, v26, v27
    v_cvt_pk_bf16_f32 v134, v28, v29
    v_cvt_pk_bf16_f32 v135, v30, v31
    buffer_store_dwordx4 v[132:135], v8, s[16:19], 0 offen offset:1024 sc1
    v_cvt_pk_bf16_f32 v136, v32, v33
    v_cvt_pk_bf16_f32 v137, v34, v35
    v_cvt_pk_bf16_f32 v138, v36, v37
    v_cvt_pk_bf16_f32 v139, v38, v39
    buffer_store_dwordx4 v[136:139], v9, s[16:19], 0 offen offset:0 sc1
    v_cvt_pk_bf16_f32 v140, v40, v41
    v_cvt_pk_bf16_f32 v141, v42, v43
    v_cvt_pk_bf16_f32 v142, v44, v45
    v_cvt_pk_bf16_f32 v143, v46, v47
    buffer_store_dwordx4 v[140:143], v9, s[16:19], 0 offen offset:1024 sc1
    v_cvt_pk_bf16_f32 v144, v48, v49
    v_cvt_pk_bf16_f32 v145, v50, v51
    v_cvt_pk_bf16_f32 v146, v52, v53
    v_cvt_pk_bf16_f32 v147, v54, v55
    buffer_store_dwordx4 v[144:147], v10, s[16:19], 0 offen offset:0 sc1
    v_cvt_pk_bf16_f32 v148, v56, v57
    v_cvt_pk_bf16_f32 v149, v58, v59
    v_cvt_pk_bf16_f32 v150, v60, v61
    v_cvt_pk_bf16_f32 v151, v62, v63
    buffer_store_dwordx4 v[148:151], v10, s[16:19], 0 offen offset:1024 sc1
    v_cvt_pk_bf16_f32 v152, v64, v65
    v_cvt_pk_bf16_f32 v153, v66, v67
    v_cvt_pk_bf16_f32 v154, v68, v69
    v_cvt_pk_bf16_f32 v155, v70, v71
    buffer_store_dwordx4 v[152:155], v11, s[16:19], 0 offen offset:0 sc1
    v_cvt_pk_bf16_f32 v156, v72, v73
    v_cvt_pk_bf16_f32 v157, v74, v75
    v_cvt_pk_bf16_f32 v158, v76, v77
    v_cvt_pk_bf16_f32 v159, v78, v79
    buffer_store_dwordx4 v[156:159], v11, s[16:19], 0 offen offset:1024 sc1
    v_cvt_pk_bf16_f32 v160, v80, v81
    v_cvt_pk_bf16_f32 v161, v82, v83
    v_cvt_pk_bf16_f32 v162, v84, v85
    v_cvt_pk_bf16_f32 v163, v86, v87
    buffer_store_dwordx4 v[160:163], v12, s[16:19], 0 offen offset:0 sc1
    v_cvt_pk_bf16_f32 v164, v88, v89
    v_cvt_pk_bf16_f32 v165, v90, v91
    v_cvt_pk_bf16_f32 v166, v92, v93
    v_cvt_pk_bf16_f32 v167, v94, v95
    buffer_store_dwordx4 v[164:167], v12, s[16:19], 0 offen offset:1024 sc1
    v_cvt_pk_bf16_f32 v168, v96, v97
    v_cvt_pk_bf16_f32 v169, v98, v99
    v_cvt_pk_bf16_f32 v170, v100, v101
    v_cvt_pk_bf16_f32 v171, v102, v103
    buffer_store_dwordx4 v[168:171], v13, s[16:19], 0 offen offset:0 sc1
    v_cvt_pk_bf16_f32 v172, v104, v105
    v_cvt_pk_bf16_f32 v173, v106, v107
    v_cvt_pk_bf16_f32 v174, v108, v109
    v_cvt_pk_bf16_f32 v175, v110, v111
    buffer_store_dwordx4 v[172:175], v13, s[16:19], 0 offen offset:1024 sc1
    v_cvt_pk_bf16_f32 v176, v112, v113
    v_cvt_pk_bf16_f32 v177, v114, v115
    v_cvt_pk_bf16_f32 v178, v116, v117
    v_cvt_pk_bf16_f32 v179, v118, v119
    buffer_store_dwordx4 v[176:179], v14, s[16:19], 0 offen offset:0 sc1
    v_cvt_pk_bf16_f32 v180, v120, v121
    v_cvt_pk_bf16_f32 v181, v122, v123
    v_cvt_pk_bf16_f32 v182, v124, v125
    v_cvt_pk_bf16_f32 v183, v126, v127
    buffer_store_dwordx4 v[180:183], v14, s[16:19], 0 offen offset:1024 sc1
    s_branch KF_p1done
K1_loader:
    s_sub_u32 s41, s30, 4
    v_lshrrev_b32 v1, 3, v0
    v_and_b32 v2, 7, v0
    v_lshlrev_b32 v21, 4, v2
    v_xor_b32 v2, v2, v1
    v_lshlrev_b32 v2, 4, v2
    s_movk_i32 s43, 1280
    v_mul_lo_u32 v1, v1, s43
    v_add_u32 v2, v2, v1
    v_add_u32 v21, v21, v1
    v_lshrrev_b32 v4, 5, v0
    s_and_b32 s44, s41, 1
    s_lshr_b32 s45, s41, 1
    s_lshl_b32 s46, s44, 1
    s_lshl_b32 s47, s45, 2
    s_or_b32 s46, s46, s47
    v_or_b32 v5, s46, v4
    v_bfe_u32 v6, v0, 1, 4
    v_xor_b32 v6, v6, v5
    v_mul_lo_u32 v7, v4, s39
    v_lshl_add_u32 v7, v6, 5, v7
    v_and_b32 v8, 1, v0
    v_lshl_add_u32 v3, v8, 4, v7
    v_mov_b32 v9, 0x80000000
    v_cmp_le_u32 vcc, 14, v6
    s_nop 1
    v_cndmask_b32 v3, v3, v9, vcc
    s_lshl_b32 s50, s41, 5
    s_add_u32 s50, s50, s40
    s_mul_i32 s50, s50, 1280
    s_add_u32 s52, s44, s47
    s_lshl_b32 s53, s52, 1
    s_mul_i32 s51, s53, s39
    s_add_u32 s51, s51, s38
    s_lshl_b32 s54, s39, 2
    s_mul_i32 s55, s39, 12
    s_lshl_b32 s56, s39, 6
    s_lshl_b32 s57, s41, 12
    s_lshl_b32 s58, s52, 10
    s_add_u32 s58, s58, 16384
    s_mov_b32 s59, 0
    s_and_b32 s46, s32, 7
    s_lshr_b32 s47, s32, 3
    s_add_u32 s46, s46, s47
    s_and_b32 s46, s46, 1
    s_mul_i32 s90, s46, 3
    s_lshl_b32 s46, s90, 7
    s_add_u32 s50, s50, s46
    s_mul_i32 s46, s90, s56
    s_add_u32 s51, s51, s46
    s_mul_i32 s91, s56, 10

    s_waitcnt lgkmcnt(0)
    s_mov_b32 s8, s4
    s_mov_b32 s9, s5
    s_mov_b32 s10, 2621440
    s_mov_b32 s11, 0x00020000
    s_mov_b32 s15, 0x00020000
    s_cmp_eq_u32 s36, 2
    s_cbranch_scc1 K1_srd_hl
    s_mov_b32 s12, s64
    s_mov_b32 s13, s65
    s_mov_b32 s14, 2457600
    s_branch K1_srd_dl
K1_srd_hl:
    s_mov_b32 s12, s24
    s_mov_b32 s13, s25
    s_mov_b32 s14, 1966080
K1_srd_dl:
    s_mov_b32 s16, s28
    s_mov_b32 s17, s29
    s_mov_b32 s18, 21836032
    s_mov_b32 s19, 0x00020000
    s_mov_b32 s92, s28
    s_mov_b32 s93, s29
    s_mov_b32 s94, 23068672
    s_mov_b32 s95, 0x00020000
    s_add_u32 s60, s59, s57
    s_add_u32 s61, s59, s58
    s_add_u32 m0, s60, 0
    s_add_u32 s62, s50, 0
    buffer_load_dwordx4 v2, s[8:11], s62 offen lds
    s_add_u32 m0, s60, 1024
    s_add_u32 s62, s50, 10240
    buffer_load_dwordx4 v2, s[8:11], s62 offen lds
    s_add_u32 m0, s60, 2048
    s_add_u32 s62, s50, 20480
    buffer_load_dwordx4 v2, s[8:11], s62 offen lds
    s_add_u32 m0, s60, 3072
    s_add_u32 s62, s50, 30720
    buffer_load_dwordx4 v2, s[8:11], s62 offen lds
    s_mov_b32 s62, s51
    s_add_u32 m0, s61, 0
    s_nop 0
    buffer_load_dwordx4 v3, s[12:15], s62 offen lds
    s_add_u32 m0, s61, 2048
    s_add_u32 s62, s62, s54
    buffer_load_dwordx4 v3, s[12:15], s62 offen lds
    s_add_u32 m0, s61, 8192
    s_add_u32 s62, s62, s55
    buffer_load_dwordx4 v3, s[12:15], s62 offen lds
    s_add_u32 m0, s61, 10240
    s_add_u32 s62, s62, s54
    buffer_load_dwordx4 v3, s[12:15], s62 offen lds
    s_add_u32 m0, s61, 16384
    s_add_u32 s62, s62, s55
    buffer_load_dwordx4 v3, s[12:15], s62 offen lds
    s_add_u32 m0, s61, 18432
    s_add_u32 s62, s62, s54
    buffer_load_dwordx4 v3, s[12:15], s62 offen lds
    s_add_u32 m0, s61, 24576
    s_add_u32 s62, s62, s55
    buffer_load_dwordx4 v3, s[12:15], s62 offen lds
    s_add_u32 m0, s61, 26624
    s_add_u32 s62, s62, s54
    buffer_load_dwordx4 v3, s[12:15], s62 offen lds
    s_add_u32 s50, s50, 128
    s_add_u32 s51, s51, s56
    s_add_u32 s90, s90, 1
    s_cmp_eq_u32 s90, 10
    s_cselect_b32 s46, 1280, 0
    s_cselect_b32 s47, s91, 0
    s_cselect_b32 s90, 0, s90
    s_sub_u32 s50, s50, s46
    s_sub_u32 s51, s51, s47
    s_add_u32 s59, s59, 49152
    s_cmp_eq_u32 s59, 147456
    s_cselect_b32 s59, 0, s59
    s_add_u32 s60, s59, s57
    s_add_u32 s61, s59, s58
    s_add_u32 m0, s60, 0
    s_add_u32 s62, s50, 0
    buffer_load_dwordx4 v2, s[8:11], s62 offen lds
    s_add_u32 m0, s60, 1024
    s_add_u32 s62, s50, 10240
    buffer_load_dwordx4 v2, s[8:11], s62 offen lds
    s_add_u32 m0, s60, 2048
    s_add_u32 s62, s50, 20480
    buffer_load_dwordx4 v2, s[8:11], s62 offen lds
    s_add_u32 m0, s60, 3072
    s_add_u32 s62, s50, 30720
    buffer_load_dwordx4 v2, s[8:11], s62 offen lds
    s_mov_b32 s62, s51
    s_add_u32 m0, s61, 0
    s_nop 0
    buffer_load_dwordx4 v3, s[12:15], s62 offen lds
    s_add_u32 m0, s61, 2048
    s_add_u32 s62, s62, s54
    buffer_load_dwordx4 v3, s[12:15], s62 offen lds
    s_add_u32 m0, s61, 8192
    s_add_u32 s62, s62, s55
    buffer_load_dwordx4 v3, s[12:15], s62 offen lds
    s_add_u32 m0, s61, 10240
    s_add_u32 s62, s62, s54
    buffer_load_dwordx4 v3, s[12:15], s62 offen lds
    s_add_u32 m0, s61, 16384
    s_add_u32 s62, s62, s55
    buffer_load_dwordx4 v3, s[12:15], s62 offen lds
    s_add_u32 m0, s61, 18432
    s_add_u32 s62, s62, s54
    buffer_load_dwordx4 v3, s[12:15], s62 offen lds
    s_add_u32 m0, s61, 24576
    s_add_u32 s62, s62, s55
    buffer_load_dwordx4 v3, s[12:15], s62 offen lds
    s_add_u32 m0, s61, 26624
    s_add_u32 s62, s62, s54
    buffer_load_dwordx4 v3, s[12:15], s62 offen lds
    s_add_u32 s50, s50, 128
    s_add_u32 s51, s51, s56
    s_add_u32 s90, s90, 1
    s_cmp_eq_u32 s90, 10
    s_cselect_b32 s46, 1280, 0
    s_cselect_b32 s47, s91, 0
    s_cselect_b32 s90, 0, s90
    s_sub_u32 s50, s50, s46
    s_sub_u32 s51, s51, s47
    s_add_u32 s59, s59, 49152
    s_cmp_eq_u32 s59, 147456
    s_cselect_b32 s59, 0, s59
    s_waitcnt vmcnt(12)
    s_barrier
    s_add_u32 s60, s59, s57
    s_add_u32 s61, s59, s58
    s_add_u32 m0, s60, 0
    s_add_u32 s62, s50, 0
    buffer_load_dwordx4 v2, s[8:11], s62 offen lds
    s_add_u32 m0, s60, 1024
    s_add_u32 s62, s50, 10240
    buffer_load_dwordx4 v2, s[8:11], s62 offen lds
    s_add_u32 m0, s60, 2048
    s_add_u32 s62, s50, 20480
    buffer_load_dwordx4 v2, s[8:11], s62 offen lds
    s_add_u32 m0, s60, 3072
    s_add_u32 s62, s50, 30720
    buffer_load_dwordx4 v2, s[8:11], s62 offen lds
    s_mov_b32 s62, s51
    s_add_u32 m0, s61, 0
    s_nop 0
    buffer_load_dwordx4 v3, s[12:15], s62 offen lds
    s_add_u32 m0, s61, 2048
    s_add_u32 s62, s62, s54
    buffer_load_dwordx4 v3, s[12:15], s62 offen lds
    s_add_u32 m0, s61, 8192
    s_add_u32 s62, s62, s55
    buffer_load_dwordx4 v3, s[12:15], s62 offen lds
    s_add_u32 m0, s61, 10240
    s_add_u32 s62, s62, s54
    buffer_load_dwordx4 v3, s[12:15], s62 offen lds
    s_add_u32 m0, s61, 16384
    s_add_u32 s62, s62, s55
    buffer_load_dwordx4 v3, s[12:15], s62 offen lds
    s_add_u32 m0, s61, 18432
    s_add_u32 s62, s62, s54
    buffer_load_dwordx4 v3, s[12:15], s62 offen lds
    s_add_u32 m0, s61, 24576
    s_add_u32 s62, s62, s55
    buffer_load_dwordx4 v3, s[12:15], s62 offen lds
    s_add_u32 m0, s61, 26624
    s_add_u32 s62, s62, s54
    buffer_load_dwordx4 v3, s[12:15], s62 offen lds
    s_add_u32 s50, s50, 128
    s_add_u32 s51, s51, s56
    s_add_u32 s90, s90, 1
    s_cmp_eq_u32 s90, 10
    s_cselect_b32 s46, 1280, 0
    s_cselect_b32 s47, s91, 0
    s_cselect_b32 s90, 0, s90
    s_sub_u32 s50, s50, s46
    s_sub_u32 s51, s51, s47
    s_add_u32 s59, s59, 49152
    s_cmp_eq_u32 s59, 147456
    s_cselect_b32 s59, 0, s59
    s_lshl_b32 s63, s2, 2
    s_add_u32 s63, s63, s41
    s_mul_hi_u32 s46, s63, 0x1999999a
    s_mul_i32 s47, s46, 10
    s_sub_u32 s47, s63, s47
    s_cmp_lt_u32 s46, 48
    s_cbranch_scc0 K1_pk_wo
    s_mov_b32 s20, s26
    s_mov_b32 s21, s27
    s_mov_b32 s22, 1966080
    s_mul_i32 s34, s46, 40960
    s_add_u32 s35, s34, 18874368
    s_lshl_b32 s46, s47, 7
    s_add_u32 s34, s34, s46
    v_mov_b32 v50, v21
    v_add_u32 v51, 10240, v21
    v_add_u32 v52, 20480, v21
    v_add_u32 v53, 30720, v21
    s_branch K1_pk_go
K1_pk_wo:
    s_mov_b32 s20, s66
    s_mov_b32 s21, s67
    s_mov_b32 s22, 819200
    s_sub_u32 s46, s46, 48
    s_mul_i32 s35, s46, 40960
    s_add_u32 s35, s35, 20840448
    s_lshl_b32 s34, s47, 7
    s_lshl_b32 s46, s46, 5
    v_lshrrev_b32 v54, 3, v0
    v_add_u32 v54, s46, v54
    s_mov_b32 s46, 0xaaaaaab
    v_and_b32 v55, 7, v0
    v_lshlrev_b32 v55, 4, v55
    v_mov_b32 v58, 0x80000000
    v_mul_hi_u32 v56, v54, s46
    v_mul_u32_u24 v57, 24, v56
    v_sub_u32 v57, v54, v57
    v_mul_u32_u24 v56, 20, v56
    v_add_u32 v56, v56, v57
    v_mul_u32_u24 v56, 1280, v56
    v_add_u32 v56, v56, v55
    v_cmp_gt_u32 vcc, 20, v57
    s_nop 1
    v_cndmask_b32 v50, v58, v56, vcc
    v_add_u32 v54, 8, v54
    v_mul_hi_u32 v56, v54, s46
    v_mul_u32_u24 v57, 24, v56
    v_sub_u32 v57, v54, v57
    v_mul_u32_u24 v56, 20, v56
    v_add_u32 v56, v56, v57
    v_mul_u32_u24 v56, 1280, v56
    v_add_u32 v56, v56, v55
    v_cmp_gt_u32 vcc, 20, v57
    s_nop 1
    v_cndmask_b32 v51, v58, v56, vcc
    v_add_u32 v54, 8, v54
    v_mul_hi_u32 v56, v54, s46
    v_mul_u32_u24 v57, 24, v56
    v_sub_u32 v57, v54, v57
    v_mul_u32_u24 v56, 20, v56
    v_add_u32 v56, v56, v57
    v_mul_u32_u24 v56, 1280, v56
    v_add_u32 v56, v56, v55
    v_cmp_gt_u32 vcc, 20, v57
    s_nop 1
    v_cndmask_b32 v52, v58, v56, vcc
    v_add_u32 v54, 8, v54
    v_mul_hi_u32 v56, v54, s46
    v_mul_u32_u24 v57, 24, v56
    v_sub_u32 v57, v54, v57
    v_mul_u32_u24 v56, 20, v56
    v_add_u32 v56, v56, v57
    v_mul_u32_u24 v56, 1280, v56
    v_add_u32 v56, v56, v55
    v_cmp_gt_u32 vcc, 20, v57
    s_nop 1
    v_cndmask_b32 v53, v58, v56, vcc
    v_add_u32 v54, 8, v54
K1_pk_go:
    s_mov_b32 s23, 0x00020000
    s_lshl_b32 s46, s47, 12
    s_add_u32 s35, s35, s46
    s_cmp_ge_u32 s63, 720
    s_cselect_b32 s35, 0x7f000000, s35
    s_cselect_b32 s34, 0x7f000000, s34
    s_add_u32 s46, s57, 147456
    s_add_u32 m0, s46, 0
    s_nop 0
    buffer_load_dwordx4 v50, s[20:23], s34 offen lds
    s_add_u32 m0, s46, 1024
    s_nop 0
    buffer_load_dwordx4 v51, s[20:23], s34 offen lds
    s_add_u32 m0, s46, 2048
    s_nop 0
    buffer_load_dwordx4 v52, s[20:23], s34 offen lds
    s_add_u32 m0, s46, 3072
    s_nop 0
    buffer_load_dwordx4 v53, s[20:23], s34 offen lds
    s_waitcnt vmcnt(16)
    s_barrier
    s_add_u32 s60, s59, s57
    s_add_u32 s61, s59, s58
    s_add_u32 m0, s60, 0
    s_add_u32 s62, s50, 0
    buffer_load_dwordx4 v2, s[8:11], s62 offen lds
    s_add_u32 m0, s60, 1024
    s_add_u32 s62, s50, 10240
    buffer_load_dwordx4 v2, s[8:11], s62 offen lds
    s_add_u32 m0, s60, 2048
    s_add_u32 s62, s50, 20480
    buffer_load_dwordx4 v2, s[8:11], s62 offen lds
    s_add_u32 m0, s60, 3072
    s_add_u32 s62, s50, 30720
    buffer_load_dwordx4 v2, s[8:11], s62 offen lds
    s_mov_b32 s62, s51
    s_add_u32 m0, s61, 0
    s_nop 0
    buffer_load_dwordx4 v3, s[12:15], s62 offen lds
    s_add_u32 m0, s61, 2048
    s_add_u32 s62, s62, s54
    buffer_load_dwordx4 v3, s[12:15], s62 offen lds
    s_add_u32 m0, s61, 8192
    s_add_u32 s62, s62, s55
    buffer_load_dwordx4 v3, s[12:15], s62 offen lds
    s_add_u32 m0, s61, 10240
    s_add_u32 s62, s62, s54
    buffer_load_dwordx4 v3, s[12:15], s62 offen lds
    s_add_u32 m0, s61, 16384
    s_add_u32 s62, s62, s55
    buffer_load_dwordx4 v3, s[12:15], s62 offen lds
    s_add_u32 m0, s61, 18432
    s_add_u32 s62, s62, s54
    buffer_load_dwordx4 v3, s[12:15], s62 offen lds
    s_add_u32 m0, s61, 24576
    s_add_u32 s62, s62, s55
    buffer_load_dwordx4 v3, s[12:15], s62 offen lds
    s_add_u32 m0, s61, 26624
    s_add_u32 s62, s62, s54
    buffer_load_dwordx4 v3, s[12:15], s62 offen lds
    s_add_u32 s50, s50, 128
    s_add_u32 s51, s51, s56
    s_add_u32 s90, s90, 1
    s_cmp_eq_u32 s90, 10
    s_cselect_b32 s46, 1280, 0
    s_cselect_b32 s47, s91, 0
    s_cselect_b32 s90, 0, s90
    s_sub_u32 s50, s50, s46
    s_sub_u32 s51, s51, s47
    s_add_u32 s59, s59, 49152
    s_cmp_eq_u32 s59, 147456
    s_cselect_b32 s59, 0, s59
    s_waitcnt vmcnt(16)
    s_barrier
    s_add_u32 s60, s59, s57
    s_add_u32 s61, s59, s58
    s_add_u32 m0, s60, 0
    s_add_u32 s62, s50, 0
    buffer_load_dwordx4 v2, s[8:11], s62 offen lds
    s_add_u32 m0, s60, 1024
    s_add_u32 s62, s50, 10240
    buffer_load_dwordx4 v2, s[8:11], s62 offen lds
    s_add_u32 m0, s60, 2048
    s_add_u32 s62, s50, 20480
    buffer_load_dwordx4 v2, s[8:11], s62 offen lds
    s_add_u32 m0, s60, 3072
    s_add_u32 s62, s50, 30720
    buffer_load_dwordx4 v2, s[8:11], s62 offen lds
    s_mov_b32 s62, s51
    s_add_u32 m0, s61, 0
    s_nop 0
    buffer_load_dwordx4 v3, s[12:15], s62 offen lds
    s_add_u32 m0, s61, 2048
    s_add_u32 s62, s62, s54
    buffer_load_dwordx4 v3, s[12:15], s62 offen lds
    s_add_u32 m0, s61, 8192
    s_add_u32 s62, s62, s55
    buffer_load_dwordx4 v3, s[12:15], s62 offen lds
    s_add_u32 m0, s61, 10240
    s_add_u32 s62, s62, s54
    buffer_load_dwordx4 v3, s[12:15], s62 offen lds
    s_add_u32 m0, s61, 16384
    s_add_u32 s62, s62, s55
    buffer_load_dwordx4 v3, s[12:15], s62 offen lds
    s_add_u32 m0, s61, 18432
    s_add_u32 s62, s62, s54
    buffer_load_dwordx4 v3, s[12:15], s62 offen lds
    s_add_u32 m0, s61, 24576
    s_add_u32 s62, s62, s55
    buffer_load_dwordx4 v3, s[12:15], s62 offen lds
    s_add_u32 m0, s61, 26624
    s_add_u32 s62, s62, s54
    buffer_load_dwordx4 v3, s[12:15], s62 offen lds
    s_add_u32 s50, s50, 128
    s_add_u32 s51, s51, s56
    s_add_u32 s90, s90, 1
    s_cmp_eq_u32 s90, 10
    s_cselect_b32 s46, 1280, 0
    s_cselect_b32 s47, s91, 0
    s_cselect_b32 s90, 0, s90
    s_sub_u32 s50, s50, s46
    s_sub_u32 s51, s51, s47
    s_add_u32 s59, s59, 49152
    s_cmp_eq_u32 s59, 147456
    s_cselect_b32 s59, 0, s59
    s_waitcnt vmcnt(12)
    s_barrier
    v_lshrrev_b32 v10, 4, v0
    v_bfe_u32 v11, v0, 2, 2
    v_lshl_add_u32 v10, v10, 3, v11
    v_lshlrev_b32 v10, 7, v10
    v_and_b32 v11, 3, v0
    v_lshl_add_u32 v10, v11, 3, v10
    s_add_u32 s46, s57, 147456
    v_add_u32 v10, s46, v10
    v_lshlrev_b32 v11, 4, v0
    ds_read_b64_tr_b16 v[24:25], v10 offset:0
    ds_read_b64_tr_b16 v[26:27], v10 offset:512
    ds_read_b64_tr_b16 v[28:29], v10 offset:32
    ds_read_b64_tr_b16 v[30:31], v10 offset:544
    ds_read_b64_tr_b16 v[32:33], v10 offset:64
    ds_read_b64_tr_b16 v[34:35], v10 offset:576
    ds_read_b64_tr_b16 v[36:37], v10 offset:96
    ds_read_b64_tr_b16 v[38:39], v10 offset:608
    s_add_u32 s60, s59, s57
    s_add_u32 s61, s59, s58
    s_add_u32 m0, s60, 0
    s_add_u32 s62, s50, 0
    buffer_load_dwordx4 v2, s[8:11], s62 offen lds
    s_add_u32 m0, s60, 1024
    s_add_u32 s62, s50, 10240
    buffer_load_dwordx4 v2, s[8:11], s62 offen lds
    s_add_u32 m0, s60, 2048
    s_add_u32 s62, s50, 20480
    buffer_load_dwordx4 v2, s[8:11], s62 offen lds
    s_add_u32 m0, s60, 3072
    s_add_u32 s62, s50, 30720
    buffer_load_dwordx4 v2, s[8:11], s62 offen lds
    s_mov_b32 s62, s51
    s_add_u32 m0, s61, 0
    s_nop 0
    buffer_load_dwordx4 v3, s[12:15], s62 offen lds
    s_add_u32 m0, s61, 2048
    s_add_u32 s62, s62, s54
    buffer_load_dwordx4 v3, s[12:15], s62 offen lds
    s_add_u32 m0, s61, 8192
    s_add_u32 s62, s62, s55
    buffer_load_dwordx4 v3, s[12:15], s62 offen lds
    s_add_u32 m0, s61, 10240
    s_add_u32 s62, s62, s54
    buffer_load_dwordx4 v3, s[12:15], s62 offen lds
    s_add_u32 m0, s61, 16384
    s_add_u32 s62, s62, s55
    buffer_load_dwordx4 v3, s[12:15], s62 offen lds
    s_add_u32 m0, s61, 18432
    s_add_u32 s62, s62, s54
    buffer_load_dwordx4 v3, s[12:15], s62 offen lds
    s_add_u32 m0, s61, 24576
    s_add_u32 s62, s62, s55
    buffer_load_dwordx4 v3, s[12:15], s62 offen lds
    s_add_u32 m0, s61, 26624
    s_add_u32 s62, s62, s54
    buffer_load_dwordx4 v3, s[12:15], s62 offen lds
    s_add_u32 s50, s50, 128
    s_add_u32 s51, s51, s56
    s_add_u32 s90, s90, 1
    s_cmp_eq_u32 s90, 10
    s_cselect_b32 s46, 1280, 0
    s_cselect_b32 s47, s91, 0
    s_cselect_b32 s90, 0, s90
    s_sub_u32 s50, s50, s46
    s_sub_u32 s51, s51, s47
    s_add_u32 s59, s59, 49152
    s_cmp_eq_u32 s59, 147456
    s_cselect_b32 s59, 0, s59
    s_waitcnt lgkmcnt(0)
    buffer_store_dwordx4 v[24:27], v11, s[16:19], s35 offen offset:0 sc1
    buffer_store_dwordx4 v[28:31], v11, s[16:19], s35 offen offset:1024 sc1
    buffer_store_dwordx4 v[32:35], v11, s[16:19], s35 offen offset:2048 sc1
    buffer_store_dwordx4 v[36:39], v11, s[16:19], s35 offen offset:3072 sc1
    s_waitcnt vmcnt(16)
    s_barrier
    s_add_u32 s60, s59, s57
    s_add_u32 s61, s59, s58
    s_add_u32 m0, s60, 0
    s_add_u32 s62, s50, 0
    buffer_load_dwordx4 v2, s[8:11], s62 offen lds
    s_add_u32 m0, s60, 1024
    s_add_u32 s62, s50, 10240
    buffer_load_dwordx4 v2, s[8:11], s62 offen lds
    s_add_u32 m0, s60, 2048
    s_add_u32 s62, s50, 20480
    buffer_load_dwordx4 v2, s[8:11], s62 offen lds
    s_add_u32 m0, s60, 3072
    s_add_u32 s62, s50, 30720
    buffer_load_dwordx4 v2, s[8:11], s62 offen lds
    s_mov_b32 s62, s51
    s_add_u32 m0, s61, 0
    s_nop 0
    buffer_load_dwordx4 v3, s[12:15], s62 offen lds
    s_add_u32 m0, s61, 2048
    s_add_u32 s62, s62, s54
    buffer_load_dwordx4 v3, s[12:15], s62 offen lds
    s_add_u32 m0, s61, 8192
    s_add_u32 s62, s62, s55
    buffer_load_dwordx4 v3, s[12:15], s62 offen lds
    s_add_u32 m0, s61, 10240
    s_add_u32 s62, s62, s54
    buffer_load_dwordx4 v3, s[12:15], s62 offen lds
    s_add_u32 m0, s61, 16384
    s_add_u32 s62, s62, s55
    buffer_load_dwordx4 v3, s[12:15], s62 offen lds
    s_add_u32 m0, s61, 18432
    s_add_u32 s62, s62, s54
    buffer_load_dwordx4 v3, s[12:15], s62 offen lds
    s_add_u32 m0, s61, 24576
    s_add_u32 s62, s62, s55
    buffer_load_dwordx4 v3, s[12:15], s62 offen lds
    s_add_u32 m0, s61, 26624
    s_add_u32 s62, s62, s54
    buffer_load_dwordx4 v3, s[12:15], s62 offen lds
    s_add_u32 s50, s50, 128
    s_add_u32 s51, s51, s56
    s_add_u32 s90, s90, 1
    s_cmp_eq_u32 s90, 10
    s_cselect_b32 s46, 1280, 0
    s_cselect_b32 s47, s91, 0
    s_cselect_b32 s90, 0, s90
    s_sub_u32 s50, s50, s46
    s_sub_u32 s51, s51, s47
    s_add_u32 s59, s59, 49152
    s_cmp_eq_u32 s59, 147456
    s_cselect_b32 s59, 0, s59
    s_waitcnt vmcnt(16)
    s_barrier
    s_add_u32 s60, s59, s57
    s_add_u32 s61, s59, s58
    s_add_u32 m0, s60, 0
    s_add_u32 s62, s50, 0
    buffer_load_dwordx4 v2, s[8:11], s62 offen lds
    s_add_u32 m0, s60, 1024
    s_add_u32 s62, s50, 10240
    buffer_load_dwordx4 v2, s[8:11], s62 offen lds
    s_add_u32 m0, s60, 2048
    s_add_u32 s62, s50, 20480
    buffer_load_dwordx4 v2, s[8:11], s62 offen lds
    s_add_u32 m0, s60, 3072
    s_add_u32 s62, s50, 30720
    buffer_load_dwordx4 v2, s[8:11], s62 offen lds
    s_mov_b32 s62, s51
    s_add_u32 m0, s61, 0
    s_nop 0
    buffer_load_dwordx4 v3, s[12:15], s62 offen lds
    s_add_u32 m0, s61, 2048
    s_add_u32 s62, s62, s54
    buffer_load_dwordx4 v3, s[12:15], s62 offen lds
    s_add_u32 m0, s61, 8192
    s_add_u32 s62, s62, s55
    buffer_load_dwordx4 v3, s[12:15], s62 offen lds
    s_add_u32 m0, s61, 10240
    s_add_u32 s62, s62, s54
    buffer_load_dwordx4 v3, s[12:15], s62 offen lds
    s_add_u32 m0, s61, 16384
    s_add_u32 s62, s62, s55
    buffer_load_dwordx4 v3, s[12:15], s62 offen lds
    s_add_u32 m0, s61, 18432
    s_add_u32 s62, s62, s54
    buffer_load_dwordx4 v3, s[12:15], s62 offen lds
    s_add_u32 m0, s61, 24576
    s_add_u32 s62, s62, s55
    buffer_load_dwordx4 v3, s[12:15], s62 offen lds
    s_add_u32 m0, s61, 26624
    s_add_u32 s62, s62, s54
    buffer_load_dwordx4 v3, s[12:15], s62 offen lds
    s_add_u32 s50, s50, 128
    s_add_u32 s51, s51, s56
    s_add_u32 s90, s90, 1
    s_cmp_eq_u32 s90, 10
    s_cselect_b32 s46, 1280, 0
    s_cselect_b32 s47, s91, 0
    s_cselect_b32 s90, 0, s90
    s_sub_u32 s50, s50, s46
    s_sub_u32 s51, s51, s47
    s_add_u32 s59, s59, 49152
    s_cmp_eq_u32 s59, 147456
    s_cselect_b32 s59, 0, s59
    s_waitcnt vmcnt(12)
    s_barrier
    s_add_u32 s60, s59, s57
    s_add_u32 s61, s59, s58
    s_add_u32 m0, s60, 0
    s_add_u32 s62, s50, 0
    buffer_load_dwordx4 v2, s[8:11], s62 offen lds
    s_add_u32 m0, s60, 1024
    s_add_u32 s62, s50, 10240
    buffer_load_dwordx4 v2, s[8:11], s62 offen lds
    s_add_u32 m0, s60, 2048
    s_add_u32 s62, s50, 20480
    buffer_load_dwordx4 v2, s[8:11], s62 offen lds
    s_add_u32 m0, s60, 3072
    s_add_u32 s62, s50, 30720
    buffer_load_dwordx4 v2, s[8:11], s62 offen lds
    s_mov_b32 s62, s51
    s_add_u32 m0, s61, 0
    s_nop 0
    buffer_load_dwordx4 v3, s[12:15], s62 offen lds
    s_add_u32 m0, s61, 2048
    s_add_u32 s62, s62, s54
    buffer_load_dwordx4 v3, s[12:15], s62 offen lds
    s_add_u32 m0, s61, 8192
    s_add_u32 s62, s62, s55
    buffer_load_dwordx4 v3, s[12:15], s62 offen lds
    s_add_u32 m0, s61, 10240
    s_add_u32 s62, s62, s54
    buffer_load_dwordx4 v3, s[12:15], s62 offen lds
    s_add_u32 m0, s61, 16384
    s_add_u32 s62, s62, s55
    buffer_load_dwordx4 v3, s[12:15], s62 offen lds
    s_add_u32 m0, s61, 18432
    s_add_u32 s62, s62, s54
    buffer_load_dwordx4 v3, s[12:15], s62 offen lds
    s_add_u32 m0, s61, 24576
    s_add_u32 s62, s62, s55
    buffer_load_dwordx4 v3, s[12:15], s62 offen lds
    s_add_u32 m0, s61, 26624
    s_add_u32 s62, s62, s54
    buffer_load_dwordx4 v3, s[12:15], s62 offen lds
    s_add_u32 s50, s50, 128
    s_add_u32 s51, s51, s56
    s_add_u32 s90, s90, 1
    s_cmp_eq_u32 s90, 10
    s_cselect_b32 s46, 1280, 0
    s_cselect_b32 s47, s91, 0
    s_cselect_b32 s90, 0, s90
    s_sub_u32 s50, s50, s46
    s_sub_u32 s51, s51, s47
    s_add_u32 s59, s59, 49152
    s_cmp_eq_u32 s59, 147456
    s_cselect_b32 s59, 0, s59
    s_waitcnt vmcnt(12)
    s_barrier
    s_add_u32 s60, s59, s57
    s_add_u32 s61, s59, s58
    s_add_u32 m0, s60, 0
    s_add_u32 s62, s50, 0
    buffer_load_dwordx4 v2, s[8:11], s62 offen lds
    s_add_u32 m0, s60, 1024
    s_add_u32 s62, s50, 10240
    buffer_load_dwordx4 v2, s[8:11], s62 offen lds
    s_add_u32 m0, s60, 2048
    s_add_u32 s62, s50, 20480
    buffer_load_dwordx4 v2, s[8:11], s62 offen lds
    s_add_u32 m0, s60, 3072
    s_add_u32 s62, s50, 30720
    buffer_load_dwordx4 v2, s[8:11], s62 offen lds
    s_mov_b32 s62, s51
    s_add_u32 m0, s61, 0
    s_nop 0
    buffer_load_dwordx4 v3, s[12:15], s62 offen lds
    s_add_u32 m0, s61, 2048
    s_add_u32 s62, s62, s54
    buffer_load_dwordx4 v3, s[12:15], s62 offen lds
    s_add_u32 m0, s61, 8192
    s_add_u32 s62, s62, s55
    buffer_load_dwordx4 v3, s[12:15], s62 offen lds
    s_add_u32 m0, s61, 10240
    s_add_u32 s62, s62, s54
    buffer_load_dwordx4 v3, s[12:15], s62 offen lds
    s_add_u32 m0, s61, 16384
    s_add_u32 s62, s62, s55
    buffer_load_dwordx4 v3, s[12:15], s62 offen lds
    s_add_u32 m0, s61, 18432
    s_add_u32 s62, s62, s54
    buffer_load_dwordx4 v3, s[12:15], s62 offen lds
    s_add_u32 m0, s61, 24576
    s_add_u32 s62, s62, s55
    buffer_load_dwordx4 v3, s[12:15], s62 offen lds
    s_add_u32 m0, s61, 26624
    s_add_u32 s62, s62, s54
    buffer_load_dwordx4 v3, s[12:15], s62 offen lds
    s_add_u32 s50, s50, 128
    s_add_u32 s51, s51, s56
    s_add_u32 s90, s90, 1
    s_cmp_eq_u32 s90, 10
    s_cselect_b32 s46, 1280, 0
    s_cselect_b32 s47, s91, 0
    s_cselect_b32 s90, 0, s90
    s_sub_u32 s50, s50, s46
    s_sub_u32 s51, s51, s47
    s_add_u32 s59, s59, 49152
    s_cmp_eq_u32 s59, 147456
    s_cselect_b32 s59, 0, s59
    s_lshr_b32 s34, s31, 1
    s_lshl_b32 s34, s34, 2
    s_lshr_b32 s35, s32, 3
    s_add_u32 s34, s34, s35
    s_lshl_b32 s44, s34, 3
    s_add_u32 s44, s44, s40
    s_lshl_b32 s45, s41, 1
    s_add_u32 s44, s44, s45
    s_mul_i32 s45, s44, 1280
    s_mov_b32 s20, s68
    s_mov_b32 s21, s69
    s_mov_b32 s22, 1280
    s_mov_b32 s23, 0x00020000
    v_lshlrev_b32 v10, 2, v0
    buffer_load_dword v16, v10, s[20:23], 0 offen offset:0
    buffer_load_dword v17, v10, s[20:23], 0 offen offset:256
    buffer_load_dword v18, v10, s[20:23], 0 offen offset:512
    buffer_load_dword v19, v10, s[20:23], 0 offen offset:768
    buffer_load_dword v20, v10, s[20:23], 0 offen offset:1024
    buffer_load_dword v24, v10, s[8:11], s45 offen offset:0
    buffer_load_dword v25, v10, s[8:11], s45 offen offset:256
    buffer_load_dword v26, v10, s[8:11], s45 offen offset:512
    buffer_load_dword v27, v10, s[8:11], s45 offen offset:768
    buffer_load_dword v28, v10, s[8:11], s45 offen offset:1024
    buffer_load_dword v32, v10, s[8:11], s45 offen offset:1280
    buffer_load_dword v33, v10, s[8:11], s45 offen offset:1536
    buffer_load_dword v34, v10, s[8:11], s45 offen offset:1792
    buffer_load_dword v35, v10, s[8:11], s45 offen offset:2048
    buffer_load_dword v36, v10, s[8:11], s45 offen offset:2304
    v_mov_b32 v15, 0x80000000
    s_lshl_b32 s46, s2, 2
    s_add_u32 s46, s46, s41
    s_lshl_b32 s46, s46, 2
    v_lshrrev_b32 v11, 4, v0
    v_add_u32 v11, s46, v11
    v_mul_u32_u24 v11, 768, v11
    v_and_b32 v12, 15, v0
    v_lshl_add_u32 v11, v12, 3, v11
    v_add_u32 v11, 3146368, v11
    v_mov_b32 v12, 0
    v_mov_b32 v13, 0
    buffer_store_dwordx2 v[12:13], v11, s[16:19], 0 offen sc1
    s_add_u32 s46, s2, s41
    s_cmp_eq_u32 s46, 0
    s_cselect_b32 s46, 8, 0
    v_lshlrev_b32 v11, 4, v0
    v_add_u32 v11, 21835776, v11
    v_cmp_gt_u32 vcc, s46, v0
    s_nop 1
    v_cndmask_b32 v11, v15, v11, vcc
    v_mov_b32 v44, 0x3f803f80
    v_mov_b32 v45, 0x3f803f80
    v_mov_b32 v46, 0x3f803f80
    v_mov_b32 v47, 0x3f803f80
    buffer_store_dwordx4 v[44:47], v11, s[16:19], 0 offen sc1
    s_cmp_eq_u32 s41, 0
    s_cselect_b32 s46, 4, 0
    s_lshl_b32 s47, s2, 4
    s_add_u32 s47, s47, 21831680
    v_lshl_add_u32 v11, v0, 2, s47
    v_cmp_gt_u32 vcc, s46, v0
    s_nop 1
    v_cndmask_b32 v11, v15, v11, vcc
    buffer_store_dword v12, v11, s[16:19], 0 offen sc1
    s_waitcnt vmcnt(30)
    s_barrier
    s_waitcnt vmcnt(18)
    s_barrier
    s_barrier
    s_waitcnt vmcnt(3)
    v_mov_b32 v40, 0
    v_dot2c_f32_bf16 v40, v16, v24
    v_dot2c_f32_bf16 v40, v17, v25
    v_dot2c_f32_bf16 v40, v18, v26
    v_dot2c_f32_bf16 v40, v19, v27
    v_dot2c_f32_bf16 v40, v20, v28
    v_mov_b32 v41, 0
    v_dot2c_f32_bf16 v41, v16, v32
    v_dot2c_f32_bf16 v41, v17, v33
    v_dot2c_f32_bf16 v41, v18, v34
    v_dot2c_f32_bf16 v41, v19, v35
    v_dot2c_f32_bf16 v41, v20, v36
    v_add_f32_dpp v40, v40, v40 quad_perm:[1,0,3,2] row_mask:0xf bank_mask:0xf
    s_nop 1
    v_add_f32_dpp v40, v40, v40 quad_perm:[2,3,0,1] row_mask:0xf bank_mask:0xf
    s_nop 1
    v_add_f32_dpp v40, v40, v40 row_half_mirror row_mask:0xf bank_mask:0xf
    s_nop 1
    v_add_f32_dpp v40, v40, v40 row_mirror row_mask:0xf bank_mask:0xf
    v_mov_b32 v43, v40
    s_nop 1
    v_permlane16_swap_b32 v43, v40
    v_add_f32 v40, v40, v43
    v_mov_b32 v43, v40
    s_nop 1
    v_permlane32_swap_b32 v43, v40
    v_add_f32 v40, v40, v43
    v_add_f32_dpp v41, v41, v41 quad_perm:[1,0,3,2] row_mask:0xf bank_mask:0xf
    s_nop 1
    v_add_f32_dpp v41, v41, v41 quad_perm:[2,3,0,1] row_mask:0xf bank_mask:0xf
    s_nop 1
    v_add_f32_dpp v41, v41, v41 row_half_mirror row_mask:0xf bank_mask:0xf
    s_nop 1
    v_add_f32_dpp v41, v41, v41 row_mirror row_mask:0xf bank_mask:0xf
    v_mov_b32 v43, v41
    s_nop 1
    v_permlane16_swap_b32 v43, v41
    v_add_f32 v41, v41, v43
    v_mov_b32 v43, v41
    s_nop 1
    v_permlane32_swap_b32 v43, v41
    v_add_f32 v41, v41, v43
    v_cmp_eq_u32 vcc, 1, v0
    s_nop 1
    v_cndmask_b32 v40, v40, v41, vcc
    v_mul_f32 v40, 0xbfb8aa3b, v40
    v_exp_f32 v40, v40
    s_nop 0
    v_add_f32 v40, 1.0, v40
    v_rcp_f32 v40, v40
    s_lshl_b32 s46, s44, 2
    s_add_u32 s46, s46, 21823488
    v_lshl_add_u32 v14, v0, 2, s46
    v_cmp_gt_u32 vcc, 2, v0
    s_nop 1
    v_cndmask_b32 v14, v15, v14, vcc
    buffer_store_dword v40, v14, s[16:19], 0 offen sc1
KF_p1done:
K1_done:
    s_endpgm

.globl k2_kernel
.p2align 8
.type k2_kernel,@function
k2_kernel:
    s_cmp_ge_u32 s2, 256
    s_cbranch_scc1 KF_done
    s_load_dwordx2 s[90:91], s[0:1], 56
    s_load_dwordx2 s[28:29], s[0:1], 72
    v_lshrrev_b32 v1, 6, v0
    v_and_b32 v0, 63, v0
    v_readfirstlane_b32 s30, v1
    s_and_b32 s31, s2, 7
    s_lshr_b32 s32, s2, 3
    v_and_b32 v1, 15, v0
    v_lshrrev_b32 v2, 4, v0
    s_mov_b32 s97, 1
    s_cmp_eq_u32 s30, 0
    s_cbranch_scc0 K2_noinit
    v_mov_b32 v8, 0
    v_mov_b32 v9, 46336
    ds_write_b32 v9, v8 offset:0
    ds_write_b32 v9, v8 offset:4
    ds_write_b32 v9, v8 offset:8
    ds_write_b32 v9, v8 offset:12
    ds_write_b32 v9, v8 offset:16
    ds_write_b32 v9, v8 offset:20
    ds_write_b32 v9, v8 offset:24
K2_noinit:
    s_cmp_ge_u32 s30, 4
    s_cbranch_scc1 K2_gemm

    s_lshr_b32 s59, s32, 2
    s_lshl_b32 s33, s59, 8
    s_and_b32 s34, s32, 3
    s_lshl_b32 s35, s31, 2
    s_add_u32 s34, s34, s35
    s_add_u32 s35, s34, 32
    s_mul_i32 s35, s35, 98304
    s_mul_i32 s40, s33, 48
    s_add_u32 s35, s35, s40
    s_sub_u32 s35, s35, 12288
    v_lshlrev_b32 v3, 4, v0
    s_mul_i32 s37, s30, 6144
    s_add_u32 s35, s35, s37
    s_cmp_eq_u32 s59, 0
    s_cselect_b32 s38, 1, 0
    s_cmp_lt_u32 s30, 2
    s_cselect_b32 s39, s38, 0
    s_waitcnt lgkmcnt(0)
    s_mov_b32 s16, s28
    s_mov_b32 s17, s29
    s_mov_b32 s18, 21836032
    s_mov_b32 s19, 0x00020000
    s_mov_b32 s92, s28
    s_mov_b32 s93, s29
    s_mov_b32 s94, 23068672
    s_mov_b32 s95, 0x00020000
    s_cmp_eq_u32 s39, 1
    s_cbranch_scc1 K2_kfill
    s_add_u32 m0, s37, 0
    s_add_u32 s40, s35, 0
    buffer_load_dwordx4 v3, s[16:19], s40 offen lds
    s_add_u32 m0, s37, 1024
    s_add_u32 s40, s35, 1024
    buffer_load_dwordx4 v3, s[16:19], s40 offen lds
    s_add_u32 m0, s37, 2048
    s_add_u32 s40, s35, 2048
    buffer_load_dwordx4 v3, s[16:19], s40 offen lds
    s_add_u32 m0, s37, 3072
    s_add_u32 s40, s35, 3072
    buffer_load_dwordx4 v3, s[16:19], s40 offen lds
    s_add_u32 m0, s37, 4096
    s_add_u32 s40, s35, 4096
    buffer_load_dwordx4 v3, s[16:19], s40 offen lds
    s_add_u32 m0, s37, 5120
    s_add_u32 s40, s35, 5120
    buffer_load_dwordx4 v3, s[16:19], s40 offen lds
    s_branch K2_kdone
K2_kfill:
    v_mov_b32 v5, 0
    v_mov_b32 v7, 0
    s_mul_i32 s40, s30, 384
    v_add_u32 v8, s40, v0
    s_mov_b32 s41, 0x5555556
    v_mul_hi_u32 v9, v8, s41
    v_mul_u32_u24 v9, 48, v9
    v_sub_u32 v9, v8, v9
    v_cmp_le_u32 vcc, 40, v9
    v_mov_b32 v6, 0x3f80
    s_nop 0
    v_cndmask_b32 v6, 0, v6, vcc
    v_mov_b32 v4, v6
    v_lshlrev_b32 v9, 4, v8
    ds_write_b128 v9, v[4:7] offset:0
    v_add_u32 v8, 64, v8
    v_mul_hi_u32 v9, v8, s41
    v_mul_u32_u24 v9, 48, v9
    v_sub_u32 v9, v8, v9
    v_cmp_le_u32 vcc, 40, v9
    v_mov_b32 v6, 0x3f80
    s_nop 0
    v_cndmask_b32 v6, 0, v6, vcc
    v_mov_b32 v4, v6
    v_lshlrev_b32 v9, 4, v8
    ds_write_b128 v9, v[4:7] offset:0
    v_add_u32 v8, 64, v8
    v_mul_hi_u32 v9, v8, s41
    v_mul_u32_u24 v9, 48, v9
    v_sub_u32 v9, v8, v9
    v_cmp_le_u32 vcc, 40, v9
    v_mov_b32 v6, 0x3f80
    s_nop 0
    v_cndmask_b32 v6, 0, v6, vcc
    v_mov_b32 v4, v6
    v_lshlrev_b32 v9, 4, v8
    ds_write_b128 v9, v[4:7] offset:0
    v_add_u32 v8, 64, v8
    v_mul_hi_u32 v9, v8, s41
    v_mul_u32_u24 v9, 48, v9
    v_sub_u32 v9, v8, v9
    v_cmp_le_u32 vcc, 40, v9
    v_mov_b32 v6, 0x3f80
    s_nop 0
    v_cndmask_b32 v6, 0, v6, vcc
    v_mov_b32 v4, v6
    v_lshlrev_b32 v9, 4, v8
    ds_write_b128 v9, v[4:7] offset:0
    v_add_u32 v8, 64, v8
    v_mul_hi_u32 v9, v8, s41
    v_mul_u32_u24 v9, 48, v9
    v_sub_u32 v9, v8, v9
    v_cmp_le_u32 vcc, 40, v9
    v_mov_b32 v6, 0x3f80
    s_nop 0
    v_cndmask_b32 v6, 0, v6, vcc
    v_mov_b32 v4, v6
    v_lshlrev_b32 v9, 4, v8
    ds_write_b128 v9, v[4:7] offset:0
    v_add_u32 v8, 64, v8
    v_mul_hi_u32 v9, v8, s41
    v_mul_u32_u24 v9, 48, v9
    v_sub_u32 v9, v8, v9
    v_cmp_le_u32 vcc, 40, v9
    v_mov_b32 v6, 0x3f80
    s_nop 0
    v_cndmask_b32 v6, 0, v6, vcc
    v_mov_b32 v4, v6
    v_lshlrev_b32 v9, 4, v8
    ds_write_b128 v9, v[4:7] offset:0
    v_add_u32 v8, 64, v8
K2_kdone:
    s_mul_i32 s36, s30, 64
    s_add_u32 s36, s36, s33
    s_mul_i32 s35, s34, 98304
    s_mul_i32 s40, s36, 48
    s_add_u32 s35, s35, s40
    v_lshlrev_b32 v4, 3, v0
    v_lshlrev_b32 v5, 3, v1
    buffer_load_dwordx2 v[80:81], v4, s[16:19], s35 offen offset:0
    buffer_load_dwordx2 v[82:83], v5, s[16:19], s35 offen offset:512
    buffer_load_dwordx2 v[84:85], v4, s[16:19], s35 offen offset:768
    buffer_load_dwordx2 v[86:87], v5, s[16:19], s35 offen offset:1280
    buffer_load_dwordx2 v[88:89], v4, s[16:19], s35 offen offset:1536
    buffer_load_dwordx2 v[90:91], v5, s[16:19], s35 offen offset:2048
    buffer_load_dwordx2 v[92:93], v4, s[16:19], s35 offen offset:2304
    buffer_load_dwordx2 v[94:95], v5, s[16:19], s35 offen offset:2816
    s_lshl_b32 s40, s36, 2
    s_add_u32 s40, s40, 21823488
    v_lshlrev_b32 v5, 2, v1
    buffer_load_dword v112, v5, s[16:19], s40 offen offset:0
    buffer_load_dword v113, v5, s[16:19], s40 offen offset:64
    buffer_load_dword v114, v5, s[16:19], s40 offen offset:128
    buffer_load_dword v115, v5, s[16:19], s40 offen offset:192
    s_lshl_b32 s40, s30, 6
    v_add_u32 v3, s40, v0
    s_mov_b32 s41, 0xc30c30d
    s_mul_i32 s43, s34, 20
    s_lshr_b32 s35, s33, 5
    s_sub_u32 s35, s35, 8
    v_mov_b32 v9, 21835776
    s_lshl_b32 s37, s30, 10
    v_mul_hi_u32 v4, v3, s41
    v_mul_u32_u24 v5, 21, v4
    v_sub_u32 v5, v3, v5
    v_lshrrev_b32 v6, 2, v4
    v_add_u32 v6, s35, v6
    v_and_b32 v4, 3, v4
    v_add_u32 v7, s43, v5
    v_lshrrev_b32 v8, 4, v7
    v_lshl_add_u32 v6, v8, 6, v6
    v_lshl_add_u32 v6, v6, 2, v4
    v_and_b32 v7, 15, v7
    v_lshlrev_b32 v7, 4, v7
    v_lshl_add_u32 v6, v6, 8, v7
    v_add_u32 v6, 6291456, v6
    v_cmp_eq_u32 vcc, 20, v5
    s_nop 1
    v_cndmask_b32 v6, v6, v9, vcc
    s_add_u32 m0, s37, 24832
    v_add_u32 v3, 256, v3
    buffer_load_dwordx4 v6, s[16:19], 0 offen lds
    v_mul_hi_u32 v4, v3, s41
    v_mul_u32_u24 v5, 21, v4
    v_sub_u32 v5, v3, v5
    v_lshrrev_b32 v6, 2, v4
    v_add_u32 v6, s35, v6
    v_and_b32 v4, 3, v4
    v_add_u32 v7, s43, v5
    v_lshrrev_b32 v8, 4, v7
    v_lshl_add_u32 v6, v8, 6, v6
    v_lshl_add_u32 v6, v6, 2, v4
    v_and_b32 v7, 15, v7
    v_lshlrev_b32 v7, 4, v7
    v_lshl_add_u32 v6, v6, 8, v7
    v_add_u32 v6, 6291456, v6
    v_cmp_eq_u32 vcc, 20, v5
    s_nop 1
    v_cndmask_b32 v6, v6, v9, vcc
    s_add_u32 m0, s37, 28928
    v_add_u32 v3, 256, v3
    buffer_load_dwordx4 v6, s[16:19], 0 offen lds
    v_mul_hi_u32 v4, v3, s41
    v_mul_u32_u24 v5, 21, v4
    v_sub_u32 v5, v3, v5
    v_lshrrev_b32 v6, 2, v4
    v_add_u32 v6, s35, v6
    v_and_b32 v4, 3, v4
    v_add_u32 v7, s43, v5
    v_lshrrev_b32 v8, 4, v7
    v_lshl_add_u32 v6, v8, 6, v6
    v_lshl_add_u32 v6, v6, 2, v4
    v_and_b32 v7, 15, v7
    v_lshlrev_b32 v7, 4, v7
    v_lshl_add_u32 v6, v6, 8, v7
    v_add_u32 v6, 6291456, v6
    v_cmp_eq_u32 vcc, 20, v5
    s_nop 1
    v_cndmask_b32 v6, v6, v9, vcc
    s_add_u32 m0, s37, 33024
    v_add_u32 v3, 256, v3
    buffer_load_dwordx4 v6, s[16:19], 0 offen lds
    v_mul_hi_u32 v4, v3, s41
    v_mul_u32_u24 v5, 21, v4
    v_sub_u32 v5, v3, v5
    v_lshrrev_b32 v6, 2, v4
    v_add_u32 v6, s35, v6
    v_and_b32 v4, 3, v4
    v_add_u32 v7, s43, v5
    v_lshrrev_b32 v8, 4, v7
    v_lshl_add_u32 v6, v8, 6, v6
    v_lshl_add_u32 v6, v6, 2, v4
    v_and_b32 v7, 15, v7
    v_lshlrev_b32 v7, 4, v7
    v_lshl_add_u32 v6, v6, 8, v7
    v_add_u32 v6, 6291456, v6
    v_cmp_eq_u32 vcc, 20, v5
    s_nop 1
    v_cndmask_b32 v6, v6, v9, vcc
    s_add_u32 m0, s37, 37120
    v_add_u32 v3, 256, v3
    buffer_load_dwordx4 v6, s[16:19], 0 offen lds
    v_mul_hi_u32 v4, v3, s41
    v_mul_u32_u24 v5, 21, v4
    v_sub_u32 v5, v3, v5
    v_lshrrev_b32 v6, 2, v4
    v_add_u32 v6, s35, v6
    v_and_b32 v4, 3, v4
    v_add_u32 v7, s43, v5
    v_lshrrev_b32 v8, 4, v7
    v_lshl_add_u32 v6, v8, 6, v6
    v_lshl_add_u32 v6, v6, 2, v4
    v_and_b32 v7, 15, v7
    v_lshlrev_b32 v7, 4, v7
    v_lshl_add_u32 v6, v6, 8, v7
    v_add_u32 v6, 6291456, v6
    v_cmp_eq_u32 vcc, 20, v5
    s_nop 1
    v_cndmask_b32 v6, v6, v9, vcc
    s_add_u32 m0, s37, 41216
    v_add_u32 v3, 256, v3
    buffer_load_dwordx4 v6, s[16:19], 0 offen lds
    s_cmp_eq_u32 s30, 0
    s_cbranch_scc0 K2_vdone
    v_mul_hi_u32 v4, v3, s41
    v_mul_u32_u24 v5, 21, v4
    v_sub_u32 v5, v3, v5
    v_lshrrev_b32 v6, 2, v4
    v_add_u32 v6, s35, v6
    v_and_b32 v4, 3, v4
    v_add_u32 v7, s43, v5
    v_lshrrev_b32 v8, 4, v7
    v_lshl_add_u32 v6, v8, 6, v6
    v_lshl_add_u32 v6, v6, 2, v4
    v_and_b32 v7, 15, v7
    v_lshlrev_b32 v7, 4, v7
    v_lshl_add_u32 v6, v6, 8, v7
    v_add_u32 v6, 6291456, v6
    v_cmp_eq_u32 vcc, 20, v5
    s_nop 1
    v_cndmask_b32 v6, v6, v9, vcc
    s_add_u32 m0, s37, 45312
    v_add_u32 v3, 256, v3
    buffer_load_dwordx4 v6, s[16:19], 0 offen lds
K2_vdone:
    s_barrier
    v_mov_b32 v3, 46336
    v_mov_b32 v4, 1
    s_mov_b64 exec, 1
    ds_add_u32 v3, v4
    s_mov_b64 exec, -1
    s_mul_i32 s40, s30, 3072
    v_lshlrev_b32 v116, 3, v0
    v_add_u32 v116, s40, v116
    v_add_u32 v117, 768, v116
    s_mul_i32 s40, s30, 2688
    s_add_u32 s40, s40, 24832
    v_mul_u32_u24 v6, 336, v2
    v_add_u32 v6, s40, v6
    v_lshl_add_u32 v118, v1, 4, v6
    v_add_u32 v7, 16, v1
    v_min_u32 v7, 20, v7
    v_lshl_add_u32 v119, v7, 4, v6
    s_mul_i32 s41, s34, 3
    v_lshrrev_b32 v6, 1, v2
    v_add_u32 v6, s41, v6
    v_lshrrev_b32 v7, 2, v6
    v_lshlrev_b32 v7, 12, v7
    v_and_b32 v8, 3, v6
    v_lshl_add_u32 v7, v8, 8, v7
    v_and_b32 v8, 1, v2
    v_lshl_add_u32 v7, v8, 10, v7
    v_lshl_add_u32 v120, v1, 4, v7
    s_add_u32 s41, s41, 2
    s_lshr_b32 s42, s41, 2
    s_lshl_b32 s42, s42, 12
    s_and_b32 s43, s41, 3
    s_lshl_b32 s43, s43, 8
    s_add_u32 s42, s42, s43
    v_lshl_add_u32 v7, v2, 10, s42
    v_lshl_add_u32 v121, v1, 4, v7
    v_mov_b32 v13, 0x80000000
    v_cmp_gt_u32 vcc, 2, v2
    s_nop 1
    v_cndmask_b32 v121, v13, v121, vcc
    s_lshr_b32 s42, s36, 6
    s_mul_i32 s42, s42, 98304
    s_add_u32 s42, s42, 15728640
    v_lshlrev_b32 v8, 2, v2
    v_sub_u32 v8, v1, v8
    v_cmp_gt_i32 s[44:45], 0, v8
    v_cmp_gt_i32 s[46:47], 1, v8
    v_cmp_gt_i32 s[48:49], 2, v8
    v_cmp_gt_i32 s[50:51], 3, v8
    v_mov_b32 v14, 0xff800000
    v_cmp_eq_u32 s[54:55], 1, v2
    v_cmp_lt_u32 s[52:53], 0, v2
    s_cmp_eq_u32 s30, 0
    s_cbranch_scc0 K2_nopad
    v_mov_b32 v8, 0
    v_lshlrev_b32 v9, 2, v0
    ds_write_b32 v9, v8 offset:24576
K2_nopad:
    v_mov_b32 v9, 0xf149
    v_mov_b32 v3, 46340
    v_mov_b32 v4, 1
    s_waitcnt vmcnt(0) lgkmcnt(0)
    s_mov_b64 exec, 1
    ds_add_u32 v3, v4
    s_mov_b64 exec, -1
    v_cndmask_b32 v82, v82, 0, s[52:53]
    v_cndmask_b32 v83, v83, 0, s[52:53]
    v_cndmask_b32 v82, v82, v9, s[54:55]
    v_cndmask_b32 v86, v86, 0, s[52:53]
    v_cndmask_b32 v87, v87, 0, s[52:53]
    v_cndmask_b32 v86, v86, v9, s[54:55]
    v_cndmask_b32 v90, v90, 0, s[52:53]
    v_cndmask_b32 v91, v91, 0, s[52:53]
    v_cndmask_b32 v90, v90, v9, s[54:55]
    v_cndmask_b32 v94, v94, 0, s[52:53]
    v_cndmask_b32 v95, v95, 0, s[52:53]
    v_cndmask_b32 v94, v94, v9, s[54:55]
K2_kwait:
    ds_read_b32 v4, v3
    s_waitcnt lgkmcnt(0)
    v_readfirstlane_b32 s58, v4
    s_nop 0
    s_cmp_lt_u32 s58, 4
    s_cbranch_scc1 K2_kwait
    s_mov_b32 s60, 0
K2_pair:
    v_mov_b32 v96, 0
    v_mov_b32 v97, 0
    v_mov_b32 v98, 0
    v_mov_b32 v99, 0
    v_mov_b32 v100, 0
    v_mov_b32 v101, 0
    v_mov_b32 v102, 0
    v_mov_b32 v103, 0
    v_mov_b32 v104, 0
    v_mov_b32 v105, 0
    v_mov_b32 v106, 0
    v_mov_b32 v107, 0
    v_mov_b32 v108, 0
    v_mov_b32 v109, 0
    v_mov_b32 v110, 0
    v_mov_b32 v111, 0
    ds_read2st64_b64 v[48:51], v116 offset0:0 offset1:1
    ds_read2st64_b64 v[52:55], v117 offset0:0 offset1:1
    ds_read_b128 v[64:67], v118
    ds_read_b128 v[68:71], v119
    s_waitcnt lgkmcnt(0)
    v_mfma_f32_16x16x32_bf16 v[16:19], v[48:51], v[80:83], 0
    v_mfma_f32_16x16x32_bf16 v[20:23], v[52:55], v[80:83], 0
    v_mfma_f32_16x16x32_bf16 v[28:31], v[52:55], v[84:87], 0
    v_add_u32 v116, 1536, v116
    v_add_u32 v117, 1536, v117
    v_add_u32 v118, 1344, v118
    v_add_u32 v119, 1344, v119
    ds_read2st64_b64 v[56:59], v116 offset0:0 offset1:1
    ds_read2st64_b64 v[60:63], v117 offset0:0 offset1:1
    ds_read_b128 v[72:75], v118
    ds_read_b128 v[76:79], v119
    v_cndmask_b32 v16, v14, v16, s[44:45]
    v_cndmask_b32 v17, v14, v17, s[46:47]
    v_cndmask_b32 v18, v14, v18, s[48:49]
    v_cndmask_b32 v19, v14, v19, s[50:51]
    v_exp_f32 v16, v16
    v_exp_f32 v17, v17
    v_exp_f32 v18, v18
    v_exp_f32 v19, v19
    v_exp_f32 v20, v20
    v_exp_f32 v21, v21
    v_exp_f32 v22, v22
    v_exp_f32 v23, v23
    v_cvt_pk_bf16_f32 v16, v16, v17
    v_cvt_pk_bf16_f32 v17, v18, v19
    v_cvt_pk_bf16_f32 v18, v20, v21
    v_cvt_pk_bf16_f32 v19, v22, v23
    v_cndmask_b32 v28, v14, v28, s[44:45]
    s_nop 0
    v_mfma_f32_16x16x32_bf16 v[96:99], v[64:67], v[16:19], v[96:99]
    v_cndmask_b32 v29, v14, v29, s[46:47]
    v_mfma_f32_16x16x32_bf16 v[100:103], v[68:71], v[16:19], v[100:103]
    v_cndmask_b32 v30, v14, v30, s[48:49]
    s_waitcnt lgkmcnt(0)
    v_mfma_f32_16x16x32_bf16 v[32:35], v[56:59], v[80:83], 0
    v_cndmask_b32 v31, v14, v31, s[50:51]
    v_mfma_f32_16x16x32_bf16 v[36:39], v[60:63], v[80:83], 0
    v_exp_f32 v28, v28
    v_mfma_f32_16x16x32_bf16 v[40:43], v[56:59], v[84:87], 0
    v_exp_f32 v29, v29
    v_mfma_f32_16x16x32_bf16 v[44:47], v[60:63], v[84:87], 0
    v_exp_f32 v30, v30
    v_exp_f32 v31, v31
    v_mov_b32 v24, 0
    v_mov_b32 v25, 0
    v_cvt_pk_bf16_f32 v26, v28, v29
    v_cvt_pk_bf16_f32 v27, v30, v31
    s_nop 1
    v_mfma_f32_16x16x32_bf16 v[104:107], v[64:67], v[24:27], v[104:107]
    v_mfma_f32_16x16x32_bf16 v[108:111], v[68:71], v[24:27], v[108:111]
    s_mov_b32 s58, 0
K2_floop:
    v_add_u32 v116, 1536, v116
    v_add_u32 v117, 1536, v117
    v_add_u32 v118, 1344, v118
    v_add_u32 v119, 1344, v119
    ds_read2st64_b64 v[48:51], v116 offset0:0 offset1:1
    ds_read2st64_b64 v[52:55], v117 offset0:0 offset1:1
    ds_read_b128 v[64:67], v118
    ds_read_b128 v[68:71], v119
    v_exp_f32 v32, v32
    v_exp_f32 v33, v33
    v_exp_f32 v34, v34
    v_exp_f32 v35, v35
    v_exp_f32 v36, v36
    v_exp_f32 v37, v37
    v_exp_f32 v38, v38
    v_exp_f32 v39, v39
    v_cvt_pk_bf16_f32 v32, v32, v33
    v_cvt_pk_bf16_f32 v33, v34, v35
    v_cvt_pk_bf16_f32 v34, v36, v37
    v_cvt_pk_bf16_f32 v35, v38, v39
    v_exp_f32 v40, v40
    s_nop 0
    v_mfma_f32_16x16x32_bf16 v[96:99], v[72:75], v[32:35], v[96:99]
    v_exp_f32 v41, v41
    v_mfma_f32_16x16x32_bf16 v[100:103], v[76:79], v[32:35], v[100:103]
    v_exp_f32 v42, v42
    s_waitcnt lgkmcnt(0)
    v_mfma_f32_16x16x32_bf16 v[16:19], v[48:51], v[80:83], 0
    v_exp_f32 v43, v43
    v_mfma_f32_16x16x32_bf16 v[20:23], v[52:55], v[80:83], 0
    v_exp_f32 v44, v44
    v_mfma_f32_16x16x32_bf16 v[24:27], v[48:51], v[84:87], 0
    v_exp_f32 v45, v45
    v_mfma_f32_16x16x32_bf16 v[28:31], v[52:55], v[84:87], 0
    v_exp_f32 v46, v46
    v_exp_f32 v47, v47
    v_cvt_pk_bf16_f32 v40, v40, v41
    v_cvt_pk_bf16_f32 v41, v42, v43
    v_cvt_pk_bf16_f32 v42, v44, v45
    v_cvt_pk_bf16_f32 v43, v46, v47
    s_nop 1
    v_mfma_f32_16x16x32_bf16 v[104:107], v[72:75], v[40:43], v[104:107]
    v_mfma_f32_16x16x32_bf16 v[108:111], v[76:79], v[40:43], v[108:111]
    v_add_u32 v116, 1536, v116
    v_add_u32 v117, 1536, v117
    v_add_u32 v118, 1344, v118
    v_add_u32 v119, 1344, v119
    ds_read2st64_b64 v[56:59], v116 offset0:0 offset1:1
    ds_read2st64_b64 v[60:63], v117 offset0:0 offset1:1
    ds_read_b128 v[72:75], v118
    ds_read_b128 v[76:79], v119
    v_exp_f32 v16, v16
    v_exp_f32 v17, v17
    v_exp_f32 v18, v18
    v_exp_f32 v19, v19
    v_exp_f32 v20, v20
    v_exp_f32 v21, v21
    v_exp_f32 v22, v22
    v_exp_f32 v23, v23
    v_cvt_pk_bf16_f32 v16, v16, v17
    v_cvt_pk_bf16_f32 v17, v18, v19
    v_cvt_pk_bf16_f32 v18, v20, v21
    v_cvt_pk_bf16_f32 v19, v22, v23
    v_exp_f32 v24, v24
    s_nop 0
    v_mfma_f32_16x16x32_bf16 v[96:99], v[64:67], v[16:19], v[96:99]
    v_exp_f32 v25, v25
    v_mfma_f32_16x16x32_bf16 v[100:103], v[68:71], v[16:19], v[100:103]
    v_exp_f32 v26, v26
    s_waitcnt lgkmcnt(0)
    v_mfma_f32_16x16x32_bf16 v[32:35], v[56:59], v[80:83], 0
    v_exp_f32 v27, v27
    v_mfma_f32_16x16x32_bf16 v[36:39], v[60:63], v[80:83], 0
    v_exp_f32 v28, v28
    v_mfma_f32_16x16x32_bf16 v[40:43], v[56:59], v[84:87], 0
    v_exp_f32 v29, v29
    v_mfma_f32_16x16x32_bf16 v[44:47], v[60:63], v[84:87], 0
    v_exp_f32 v30, v30
    v_exp_f32 v31, v31
    v_cvt_pk_bf16_f32 v24, v24, v25
    v_cvt_pk_bf16_f32 v25, v26, v27
    v_cvt_pk_bf16_f32 v26, v28, v29
    v_cvt_pk_bf16_f32 v27, v30, v31
    s_nop 1
    v_mfma_f32_16x16x32_bf16 v[104:107], v[64:67], v[24:27], v[104:107]
    v_mfma_f32_16x16x32_bf16 v[108:111], v[68:71], v[24:27], v[108:111]
    s_add_u32 s58, s58, 1
    s_cmp_lt_u32 s58, 3
    s_cbranch_scc1 K2_floop
    v_add_u32 v116, 1536, v116
    v_add_u32 v117, 1536, v117
    v_add_u32 v118, 1344, v118
    v_add_u32 v119, 1344, v119
    ds_read2st64_b64 v[48:51], v116 offset0:0 offset1:1
    ds_read2st64_b64 v[52:55], v117 offset0:0 offset1:1
    ds_read_b128 v[64:67], v118
    ds_read_b128 v[68:71], v119
    v_exp_f32 v32, v32
    v_exp_f32 v33, v33
    v_exp_f32 v34, v34
    v_exp_f32 v35, v35
    v_exp_f32 v36, v36
    v_exp_f32 v37, v37
    v_exp_f32 v38, v38
    v_exp_f32 v39, v39
    v_cvt_pk_bf16_f32 v32, v32, v33
    v_cvt_pk_bf16_f32 v33, v34, v35
    v_cvt_pk_bf16_f32 v34, v36, v37
    v_cvt_pk_bf16_f32 v35, v38, v39
    v_exp_f32 v40, v40
    s_nop 0
    v_mfma_f32_16x16x32_bf16 v[96:99], v[72:75], v[32:35], v[96:99]
    v_exp_f32 v41, v41
    v_mfma_f32_16x16x32_bf16 v[100:103], v[76:79], v[32:35], v[100:103]
    v_exp_f32 v42, v42
    s_waitcnt lgkmcnt(0)
    v_mfma_f32_16x16x32_bf16 v[16:19], v[48:51], v[80:83], 0
    v_exp_f32 v43, v43
    v_mfma_f32_16x16x32_bf16 v[24:27], v[48:51], v[84:87], 0
    v_exp_f32 v44, v44
    v_mfma_f32_16x16x32_bf16 v[28:31], v[52:55], v[84:87], 0
    v_exp_f32 v45, v45
    v_exp_f32 v46, v46
    v_exp_f32 v47, v47
    v_cvt_pk_bf16_f32 v40, v40, v41
    v_cvt_pk_bf16_f32 v41, v42, v43
    v_cvt_pk_bf16_f32 v42, v44, v45
    v_cvt_pk_bf16_f32 v43, v46, v47
    s_nop 1
    v_mfma_f32_16x16x32_bf16 v[104:107], v[72:75], v[40:43], v[104:107]
    v_mfma_f32_16x16x32_bf16 v[108:111], v[76:79], v[40:43], v[108:111]
    v_cndmask_b32 v16, v16, v14, s[44:45]
    v_cndmask_b32 v17, v17, v14, s[46:47]
    v_cndmask_b32 v18, v18, v14, s[48:49]
    v_cndmask_b32 v19, v19, v14, s[50:51]
    v_exp_f32 v16, v16
    v_exp_f32 v17, v17
    v_exp_f32 v18, v18
    v_exp_f32 v19, v19
    v_cvt_pk_bf16_f32 v16, v16, v17
    v_cvt_pk_bf16_f32 v17, v18, v19
    v_mov_b32 v18, 0
    v_mov_b32 v19, 0
    v_exp_f32 v24, v24
    s_nop 0
    v_mfma_f32_16x16x32_bf16 v[96:99], v[64:67], v[16:19], v[96:99]
    v_exp_f32 v25, v25
    v_mfma_f32_16x16x32_bf16 v[100:103], v[68:71], v[16:19], v[100:103]
    v_exp_f32 v26, v26
    v_exp_f32 v27, v27
    v_cndmask_b32 v28, v28, v14, s[44:45]
    v_cndmask_b32 v29, v29, v14, s[46:47]
    v_cndmask_b32 v30, v30, v14, s[48:49]
    v_cndmask_b32 v31, v31, v14, s[50:51]
    v_exp_f32 v28, v28
    v_exp_f32 v29, v29
    v_exp_f32 v30, v30
    v_exp_f32 v31, v31
    v_cvt_pk_bf16_f32 v24, v24, v25
    v_cvt_pk_bf16_f32 v25, v26, v27
    v_cvt_pk_bf16_f32 v26, v28, v29
    v_cvt_pk_bf16_f32 v27, v30, v31
    s_nop 1
    v_mfma_f32_16x16x32_bf16 v[104:107], v[64:67], v[24:27], v[104:107]
    v_mfma_f32_16x16x32_bf16 v[108:111], v[68:71], v[24:27], v[108:111]
    v_mov_b32 v3, v100
    v_mov_b32 v4, v100
    s_nop 1
    v_permlane16_swap_b32 v4, v3
    v_mov_b32 v4, v3
    s_nop 1
    v_permlane32_swap_b32 v4, v3
    v_mov_b32 v5, v108
    v_mov_b32 v6, v108
    s_nop 1
    v_permlane16_swap_b32 v6, v5
    v_mov_b32 v6, v5
    s_nop 1
    v_permlane32_swap_b32 v6, v5
    v_min_f32 v7, v4, v6
    v_max_f32 v8, v4, v6
    s_mov_b32 s61, 0x17800000
    s_mov_b32 s62, 0x5d800000
    v_cmp_nle_f32 vcc, s61, v7
    s_nop 0
    s_mov_b64 s[56:57], vcc
    v_cmp_nge_f32 vcc, s62, v8
    s_nop 0
    s_or_b64 s[56:57], s[56:57], vcc
    s_cmp_lg_u64 s[56:57], 0
    s_cbranch_scc1 K2_fallback
K2_fin:
    v_rcp_f32 v4, v4
    v_rcp_f32 v6, v6
    v_mul_f32 v4, v4, v112
    v_mul_f32 v6, v6, v113
    v_mul_f32 v96, v96, v4
    v_mul_f32 v97, v97, v4
    v_mul_f32 v98, v98, v4
    v_mul_f32 v99, v99, v4
    v_mul_f32 v100, v100, v4
    v_mul_f32 v101, v101, v4
    v_mul_f32 v102, v102, v4
    v_mul_f32 v103, v103, v4
    v_mul_f32 v104, v104, v6
    v_mul_f32 v105, v105, v6
    v_mul_f32 v106, v106, v6
    v_mul_f32 v107, v107, v6
    v_mul_f32 v108, v108, v6
    v_mul_f32 v109, v109, v6
    v_mul_f32 v110, v110, v6
    v_mul_f32 v111, v111, v6
    v_cvt_pk_bf16_f32 v16, v96, v97
    v_cvt_pk_bf16_f32 v17, v98, v99
    v_cvt_pk_bf16_f32 v18, v104, v105
    v_cvt_pk_bf16_f32 v19, v106, v107
    v_cvt_pk_bf16_f32 v20, v100, v101
    v_cvt_pk_bf16_f32 v21, v102, v103
    v_cvt_pk_bf16_f32 v24, v108, v109
    v_cvt_pk_bf16_f32 v25, v110, v111
    v_mov_b32 v22, 0
    v_mov_b32 v23, 0
    v_permlane16_swap_b32 v16, v18
    v_permlane16_swap_b32 v17, v19
    v_permlane16_swap_b32 v20, v24
    v_permlane16_swap_b32 v21, v25
    buffer_store_dwordx4 v[16:19], v120, s[16:19], s42 offen sc1
    buffer_store_dwordx4 v[20:23], v121, s[16:19], s42 offen sc1
    s_add_u32 s42, s42, 2048
    s_add_u32 s60, s60, 1
    s_cmp_ge_u32 s60, 2
    s_cbranch_scc1 K2_attn_end
    v_add_u32 v116, 4294956544, v116
    v_add_u32 v117, 4294956544, v117
    v_add_u32 v118, 4294957888, v118
    v_add_u32 v119, 4294957888, v119
    v_mov_b32 v80, v88
    v_mov_b32 v81, v89
    v_mov_b32 v82, v90
    v_mov_b32 v83, v91
    v_mov_b32 v84, v92
    v_mov_b32 v85, v93
    v_mov_b32 v86, v94
    v_mov_b32 v87, v95
    v_mov_b32 v112, v114
    v_mov_b32 v113, v115
    s_branch K2_pair
K2_attn_end:
    s_lshr_b32 s58, s36, 6
    s_lshl_b32 s58, s58, 5
    s_add_u32 s58, s58, s34
    s_lshl_b32 s58, s58, 2
    s_add_u32 s58, s58, 21831680
    v_mov_b32 v3, s58
    v_mov_b32 v4, 1
    s_waitcnt vmcnt(0)
    s_mov_b64 exec, 1
    buffer_store_dword v4, v3, s[16:19], 0 offen sc1
    s_mov_b64 exec, -1
    s_branch KF_done
K2_gemm:
    s_sub_u32 s33, s30, 4
    s_lshr_b32 s34, s31, 1
    s_lshl_b32 s34, s34, 3
    s_and_b32 s35, s32, 7
    s_add_u32 s34, s34, s35
    s_and_b32 s35, s31, 1
    s_lshl_b32 s35, s35, 2
    s_lshr_b32 s46, s32, 3
    s_add_u32 s35, s35, s46
    s_lshl_b32 s36, s34, 6
    s_mul_i32 s43, s35, 5
    v_lshlrev_b32 v240, 4, v0
    v_add_u32 v241, 4096, v240
    s_waitcnt lgkmcnt(0)
    s_mov_b32 s16, s28
    s_mov_b32 s17, s29
    s_mov_b32 s18, 21836032
    s_mov_b32 s19, 0x00020000
    s_mov_b32 s92, s28
    s_mov_b32 s93, s29
    s_mov_b32 s94, 23068672
    s_mov_b32 s95, 0x00020000
    s_barrier
    s_mov_b32 s20, s90
    s_mov_b32 s21, s91
    s_mov_b32 s22, 2621440
    s_mov_b32 s23, 0x00020000
    s_mul_i32 s41, s34, 48
    s_mul_i32 s42, s33, 12
    s_add_u32 s41, s41, s42
    s_lshl_b32 s41, s41, 12
    s_add_u32 s41, s41, 9437184
    s_mul_i32 s42, s42, 40
    s_add_u32 s42, s42, s43
    s_lshl_b32 s42, s42, 10
    s_add_u32 s42, s42, 18874368
    s_lshl_b32 s40, s36, 2
    s_add_u32 s40, s40, 21823488
    v_lshlrev_b32 v3, 2, v1
    buffer_load_dword v12, v3, s[16:19], s40 offen offset:0
    buffer_load_dword v13, v3, s[16:19], s40 offen offset:64
    buffer_load_dword v14, v3, s[16:19], s40 offen offset:128
    buffer_load_dword v15, v3, s[16:19], s40 offen offset:192
    v_mov_b32 v8, 46340
K2_gwait:
    ds_read_b32 v9, v8
    s_waitcnt lgkmcnt(0)
    v_readfirstlane_b32 s58, v9
    s_nop 0
    s_cmp_lt_u32 s58, 4
    s_cbranch_scc0 K2_gwait_ok
    s_sleep 2
    s_branch K2_gwait
K2_gwait_ok:
    buffer_load_dwordx4 v[112:115], v240, s[16:19], s42 offen offset:0
    buffer_load_dwordx4 v[116:119], v240, s[16:19], s42 offen offset:1024
    buffer_load_dwordx4 v[120:123], v240, s[16:19], s42 offen offset:2048
    buffer_load_dwordx4 v[124:127], v240, s[16:19], s42 offen offset:3072
    buffer_load_dwordx4 v[128:131], v241, s[16:19], s42 offen
    s_add_u32 s42, s42, 40960
    buffer_load_dwordx4 v[96:99], v240, s[16:19], s41 offen offset:0
    buffer_load_dwordx4 v[100:103], v240, s[16:19], s41 offen offset:1024
    buffer_load_dwordx4 v[104:107], v240, s[16:19], s41 offen offset:2048
    buffer_load_dwordx4 v[108:111], v240, s[16:19], s41 offen offset:3072
    s_add_u32 s41, s41, 4096
    buffer_load_dwordx4 v[148:151], v240, s[16:19], s42 offen offset:0
    buffer_load_dwordx4 v[152:155], v240, s[16:19], s42 offen offset:1024
    buffer_load_dwordx4 v[156:159], v240, s[16:19], s42 offen offset:2048
    buffer_load_dwordx4 v[160:163], v240, s[16:19], s42 offen offset:3072
    buffer_load_dwordx4 v[164:167], v241, s[16:19], s42 offen
    s_add_u32 s42, s42, 40960
    buffer_load_dwordx4 v[132:135], v240, s[16:19], s41 offen offset:0
    buffer_load_dwordx4 v[136:139], v240, s[16:19], s41 offen offset:1024
    buffer_load_dwordx4 v[140:143], v240, s[16:19], s41 offen offset:2048
    buffer_load_dwordx4 v[144:147], v240, s[16:19], s41 offen offset:3072
    s_add_u32 s41, s41, 4096
    buffer_load_dwordx4 v[184:187], v240, s[16:19], s42 offen offset:0
    buffer_load_dwordx4 v[188:191], v240, s[16:19], s42 offen offset:1024
    buffer_load_dwordx4 v[192:195], v240, s[16:19], s42 offen offset:2048
    buffer_load_dwordx4 v[196:199], v240, s[16:19], s42 offen offset:3072
    buffer_load_dwordx4 v[200:203], v241, s[16:19], s42 offen
    s_add_u32 s42, s42, 40960
    buffer_load_dwordx4 v[168:171], v240, s[16:19], s41 offen offset:0
    buffer_load_dwordx4 v[172:175], v240, s[16:19], s41 offen offset:1024
    buffer_load_dwordx4 v[176:179], v240, s[16:19], s41 offen offset:2048
    buffer_load_dwordx4 v[180:183], v240, s[16:19], s41 offen offset:3072
    s_add_u32 s41, s41, 4096
    s_waitcnt vmcnt(18)
    v_mfma_f32_16x16x32_bf16 v[16:19], v[112:115], v[96:99], 0
    v_mfma_f32_16x16x32_bf16 v[20:23], v[112:115], v[100:103], 0
    buffer_load_dwordx4 v[204:207], v240, s[16:19], s41 offen offset:0
    v_mfma_f32_16x16x32_bf16 v[24:27], v[112:115], v[104:107], 0
    v_mfma_f32_16x16x32_bf16 v[28:31], v[112:115], v[108:111], 0
    buffer_load_dwordx4 v[208:211], v240, s[16:19], s41 offen offset:1024
    v_mfma_f32_16x16x32_bf16 v[32:35], v[116:119], v[96:99], 0
    v_mfma_f32_16x16x32_bf16 v[36:39], v[116:119], v[100:103], 0
    buffer_load_dwordx4 v[212:215], v240, s[16:19], s41 offen offset:2048
    v_mfma_f32_16x16x32_bf16 v[40:43], v[116:119], v[104:107], 0
    v_mfma_f32_16x16x32_bf16 v[44:47], v[116:119], v[108:111], 0
    buffer_load_dwordx4 v[216:219], v240, s[16:19], s41 offen offset:3072
    s_add_u32 s41, s41, 4096
    v_mfma_f32_16x16x32_bf16 v[48:51], v[120:123], v[96:99], 0
    v_mfma_f32_16x16x32_bf16 v[52:55], v[120:123], v[100:103], 0
    buffer_load_dwordx4 v[220:223], v240, s[16:19], s42 offen offset:0
    v_mfma_f32_16x16x32_bf16 v[56:59], v[120:123], v[104:107], 0
    v_mfma_f32_16x16x32_bf16 v[60:63], v[120:123], v[108:111], 0
    buffer_load_dwordx4 v[224:227], v240, s[16:19], s42 offen offset:1024
    v_mfma_f32_16x16x32_bf16 v[64:67], v[124:127], v[96:99], 0
    v_mfma_f32_16x16x32_bf16 v[68:71], v[124:127], v[100:103], 0
    buffer_load_dwordx4 v[228:231], v240, s[16:19], s42 offen offset:2048
    v_mfma_f32_16x16x32_bf16 v[72:75], v[124:127], v[104:107], 0
    v_mfma_f32_16x16x32_bf16 v[76:79], v[124:127], v[108:111], 0
    buffer_load_dwordx4 v[232:235], v240, s[16:19], s42 offen offset:3072
    v_mfma_f32_16x16x32_bf16 v[80:83], v[128:131], v[96:99], 0
    v_mfma_f32_16x16x32_bf16 v[84:87], v[128:131], v[100:103], 0
    buffer_load_dwordx4 v[236:239], v241, s[16:19], s42 offen
    s_add_u32 s42, s42, 40960
    v_mfma_f32_16x16x32_bf16 v[88:91], v[128:131], v[104:107], 0
    v_mfma_f32_16x16x32_bf16 v[92:95], v[128:131], v[108:111], 0
    s_waitcnt vmcnt(18)
    v_mfma_f32_16x16x32_bf16 v[16:19], v[148:151], v[132:135], v[16:19]
    v_mfma_f32_16x16x32_bf16 v[20:23], v[148:151], v[136:139], v[20:23]
    buffer_load_dwordx4 v[96:99], v240, s[16:19], s41 offen offset:0
    v_mfma_f32_16x16x32_bf16 v[24:27], v[148:151], v[140:143], v[24:27]
    v_mfma_f32_16x16x32_bf16 v[28:31], v[148:151], v[144:147], v[28:31]
    buffer_load_dwordx4 v[100:103], v240, s[16:19], s41 offen offset:1024
    v_mfma_f32_16x16x32_bf16 v[32:35], v[152:155], v[132:135], v[32:35]
    v_mfma_f32_16x16x32_bf16 v[36:39], v[152:155], v[136:139], v[36:39]
    buffer_load_dwordx4 v[104:107], v240, s[16:19], s41 offen offset:2048
    v_mfma_f32_16x16x32_bf16 v[40:43], v[152:155], v[140:143], v[40:43]
    v_mfma_f32_16x16x32_bf16 v[44:47], v[152:155], v[144:147], v[44:47]
    buffer_load_dwordx4 v[108:111], v240, s[16:19], s41 offen offset:3072
    s_add_u32 s41, s41, 4096
    v_mfma_f32_16x16x32_bf16 v[48:51], v[156:159], v[132:135], v[48:51]
    v_mfma_f32_16x16x32_bf16 v[52:55], v[156:159], v[136:139], v[52:55]
    buffer_load_dwordx4 v[112:115], v240, s[16:19], s42 offen offset:0
    v_mfma_f32_16x16x32_bf16 v[56:59], v[156:159], v[140:143], v[56:59]
    v_mfma_f32_16x16x32_bf16 v[60:63], v[156:159], v[144:147], v[60:63]
    buffer_load_dwordx4 v[116:119], v240, s[16:19], s42 offen offset:1024
    v_mfma_f32_16x16x32_bf16 v[64:67], v[160:163], v[132:135], v[64:67]
    v_mfma_f32_16x16x32_bf16 v[68:71], v[160:163], v[136:139], v[68:71]
    buffer_load_dwordx4 v[120:123], v240, s[16:19], s42 offen offset:2048
    v_mfma_f32_16x16x32_bf16 v[72:75], v[160:163], v[140:143], v[72:75]
    v_mfma_f32_16x16x32_bf16 v[76:79], v[160:163], v[144:147], v[76:79]
    buffer_load_dwordx4 v[124:127], v240, s[16:19], s42 offen offset:3072
    v_mfma_f32_16x16x32_bf16 v[80:83], v[164:167], v[132:135], v[80:83]
    v_mfma_f32_16x16x32_bf16 v[84:87], v[164:167], v[136:139], v[84:87]
    buffer_load_dwordx4 v[128:131], v241, s[16:19], s42 offen
    s_add_u32 s42, s42, 40960
    v_mfma_f32_16x16x32_bf16 v[88:91], v[164:167], v[140:143], v[88:91]
    v_mfma_f32_16x16x32_bf16 v[92:95], v[164:167], v[144:147], v[92:95]
    s_waitcnt vmcnt(18)
    v_mfma_f32_16x16x32_bf16 v[16:19], v[184:187], v[168:171], v[16:19]
    v_mfma_f32_16x16x32_bf16 v[20:23], v[184:187], v[172:175], v[20:23]
    buffer_load_dwordx4 v[132:135], v240, s[16:19], s41 offen offset:0
    v_mfma_f32_16x16x32_bf16 v[24:27], v[184:187], v[176:179], v[24:27]
    v_mfma_f32_16x16x32_bf16 v[28:31], v[184:187], v[180:183], v[28:31]
    buffer_load_dwordx4 v[136:139], v240, s[16:19], s41 offen offset:1024
    v_mfma_f32_16x16x32_bf16 v[32:35], v[188:191], v[168:171], v[32:35]
    v_mfma_f32_16x16x32_bf16 v[36:39], v[188:191], v[172:175], v[36:39]
    buffer_load_dwordx4 v[140:143], v240, s[16:19], s41 offen offset:2048
    v_mfma_f32_16x16x32_bf16 v[40:43], v[188:191], v[176:179], v[40:43]
    v_mfma_f32_16x16x32_bf16 v[44:47], v[188:191], v[180:183], v[44:47]
    buffer_load_dwordx4 v[144:147], v240, s[16:19], s41 offen offset:3072
    s_add_u32 s41, s41, 4096
    v_mfma_f32_16x16x32_bf16 v[48:51], v[192:195], v[168:171], v[48:51]
    v_mfma_f32_16x16x32_bf16 v[52:55], v[192:195], v[172:175], v[52:55]
    buffer_load_dwordx4 v[148:151], v240, s[16:19], s42 offen offset:0
    v_mfma_f32_16x16x32_bf16 v[56:59], v[192:195], v[176:179], v[56:59]
    v_mfma_f32_16x16x32_bf16 v[60:63], v[192:195], v[180:183], v[60:63]
    buffer_load_dwordx4 v[152:155], v240, s[16:19], s42 offen offset:1024
    v_mfma_f32_16x16x32_bf16 v[64:67], v[196:199], v[168:171], v[64:67]
    v_mfma_f32_16x16x32_bf16 v[68:71], v[196:199], v[172:175], v[68:71]
    buffer_load_dwordx4 v[156:159], v240, s[16:19], s42 offen offset:2048
    v_mfma_f32_16x16x32_bf16 v[72:75], v[196:199], v[176:179], v[72:75]
    v_mfma_f32_16x16x32_bf16 v[76:79], v[196:199], v[180:183], v[76:79]
    buffer_load_dwordx4 v[160:163], v240, s[16:19], s42 offen offset:3072
    v_mfma_f32_16x16x32_bf16 v[80:83], v[200:203], v[168:171], v[80:83]
    v_mfma_f32_16x16x32_bf16 v[84:87], v[200:203], v[172:175], v[84:87]
    buffer_load_dwordx4 v[164:167], v241, s[16:19], s42 offen
    s_add_u32 s42, s42, 40960
    v_mfma_f32_16x16x32_bf16 v[88:91], v[200:203], v[176:179], v[88:91]
    v_mfma_f32_16x16x32_bf16 v[92:95], v[200:203], v[180:183], v[92:95]
    s_waitcnt vmcnt(18)
    v_mfma_f32_16x16x32_bf16 v[16:19], v[220:223], v[204:207], v[16:19]
    v_mfma_f32_16x16x32_bf16 v[20:23], v[220:223], v[208:211], v[20:23]
    buffer_load_dwordx4 v[168:171], v240, s[16:19], s41 offen offset:0
    v_mfma_f32_16x16x32_bf16 v[24:27], v[220:223], v[212:215], v[24:27]
    v_mfma_f32_16x16x32_bf16 v[28:31], v[220:223], v[216:219], v[28:31]
    buffer_load_dwordx4 v[172:175], v240, s[16:19], s41 offen offset:1024
    v_mfma_f32_16x16x32_bf16 v[32:35], v[224:227], v[204:207], v[32:35]
    v_mfma_f32_16x16x32_bf16 v[36:39], v[224:227], v[208:211], v[36:39]
    buffer_load_dwordx4 v[176:179], v240, s[16:19], s41 offen offset:2048
    v_mfma_f32_16x16x32_bf16 v[40:43], v[224:227], v[212:215], v[40:43]
    v_mfma_f32_16x16x32_bf16 v[44:47], v[224:227], v[216:219], v[44:47]
    buffer_load_dwordx4 v[180:183], v240, s[16:19], s41 offen offset:3072
    s_add_u32 s41, s41, 4096
    v_mfma_f32_16x16x32_bf16 v[48:51], v[228:231], v[204:207], v[48:51]
    v_mfma_f32_16x16x32_bf16 v[52:55], v[228:231], v[208:211], v[52:55]
    buffer_load_dwordx4 v[184:187], v240, s[16:19], s42 offen offset:0
    v_mfma_f32_16x16x32_bf16 v[56:59], v[228:231], v[212:215], v[56:59]
    v_mfma_f32_16x16x32_bf16 v[60:63], v[228:231], v[216:219], v[60:63]
    buffer_load_dwordx4 v[188:191], v240, s[16:19], s42 offen offset:1024
    v_mfma_f32_16x16x32_bf16 v[64:67], v[232:235], v[204:207], v[64:67]
    v_mfma_f32_16x16x32_bf16 v[68:71], v[232:235], v[208:211], v[68:71]
    buffer_load_dwordx4 v[192:195], v240, s[16:19], s42 offen offset:2048
    v_mfma_f32_16x16x32_bf16 v[72:75], v[232:235], v[212:215], v[72:75]
    v_mfma_f32_16x16x32_bf16 v[76:79], v[232:235], v[216:219], v[76:79]
    buffer_load_dwordx4 v[196:199], v240, s[16:19], s42 offen offset:3072
    v_mfma_f32_16x16x32_bf16 v[80:83], v[236:239], v[204:207], v[80:83]
    v_mfma_f32_16x16x32_bf16 v[84:87], v[236:239], v[208:211], v[84:87]
    buffer_load_dwordx4 v[200:203], v241, s[16:19], s42 offen
    s_add_u32 s42, s42, 40960
    v_mfma_f32_16x16x32_bf16 v[88:91], v[236:239], v[212:215], v[88:91]
    v_mfma_f32_16x16x32_bf16 v[92:95], v[236:239], v[216:219], v[92:95]
    s_waitcnt vmcnt(18)
    v_mfma_f32_16x16x32_bf16 v[16:19], v[112:115], v[96:99], v[16:19]
    v_mfma_f32_16x16x32_bf16 v[20:23], v[112:115], v[100:103], v[20:23]
    buffer_load_dwordx4 v[204:207], v240, s[16:19], s41 offen offset:0
    v_mfma_f32_16x16x32_bf16 v[24:27], v[112:115], v[104:107], v[24:27]
    v_mfma_f32_16x16x32_bf16 v[28:31], v[112:115], v[108:111], v[28:31]
    buffer_load_dwordx4 v[208:211], v240, s[16:19], s41 offen offset:1024
    v_mfma_f32_16x16x32_bf16 v[32:35], v[116:119], v[96:99], v[32:35]
    v_mfma_f32_16x16x32_bf16 v[36:39], v[116:119], v[100:103], v[36:39]
    buffer_load_dwordx4 v[212:215], v240, s[16:19], s41 offen offset:2048
    v_mfma_f32_16x16x32_bf16 v[40:43], v[116:119], v[104:107], v[40:43]
    v_mfma_f32_16x16x32_bf16 v[44:47], v[116:119], v[108:111], v[44:47]
    buffer_load_dwordx4 v[216:219], v240, s[16:19], s41 offen offset:3072
    s_add_u32 s41, s41, 4096
    v_mfma_f32_16x16x32_bf16 v[48:51], v[120:123], v[96:99], v[48:51]
    v_mfma_f32_16x16x32_bf16 v[52:55], v[120:123], v[100:103], v[52:55]
    buffer_load_dwordx4 v[220:223], v240, s[16:19], s42 offen offset:0
    v_mfma_f32_16x16x32_bf16 v[56:59], v[120:123], v[104:107], v[56:59]
    v_mfma_f32_16x16x32_bf16 v[60:63], v[120:123], v[108:111], v[60:63]
    buffer_load_dwordx4 v[224:227], v240, s[16:19], s42 offen offset:1024
    v_mfma_f32_16x16x32_bf16 v[64:67], v[124:127], v[96:99], v[64:67]
    v_mfma_f32_16x16x32_bf16 v[68:71], v[124:127], v[100:103], v[68:71]
    buffer_load_dwordx4 v[228:231], v240, s[16:19], s42 offen offset:2048
    v_mfma_f32_16x16x32_bf16 v[72:75], v[124:127], v[104:107], v[72:75]
    v_mfma_f32_16x16x32_bf16 v[76:79], v[124:127], v[108:111], v[76:79]
    buffer_load_dwordx4 v[232:235], v240, s[16:19], s42 offen offset:3072
    v_mfma_f32_16x16x32_bf16 v[80:83], v[128:131], v[96:99], v[80:83]
    v_mfma_f32_16x16x32_bf16 v[84:87], v[128:131], v[100:103], v[84:87]
    buffer_load_dwordx4 v[236:239], v241, s[16:19], s42 offen
    s_add_u32 s42, s42, 40960
    v_mfma_f32_16x16x32_bf16 v[88:91], v[128:131], v[104:107], v[88:91]
    v_mfma_f32_16x16x32_bf16 v[92:95], v[128:131], v[108:111], v[92:95]
    s_waitcnt vmcnt(18)
    v_mfma_f32_16x16x32_bf16 v[16:19], v[148:151], v[132:135], v[16:19]
    v_mfma_f32_16x16x32_bf16 v[20:23], v[148:151], v[136:139], v[20:23]
    buffer_load_dwordx4 v[96:99], v240, s[16:19], s41 offen offset:0
    v_mfma_f32_16x16x32_bf16 v[24:27], v[148:151], v[140:143], v[24:27]
    v_mfma_f32_16x16x32_bf16 v[28:31], v[148:151], v[144:147], v[28:31]
    buffer_load_dwordx4 v[100:103], v240, s[16:19], s41 offen offset:1024
    v_mfma_f32_16x16x32_bf16 v[32:35], v[152:155], v[132:135], v[32:35]
    v_mfma_f32_16x16x32_bf16 v[36:39], v[152:155], v[136:139], v[36:39]
    buffer_load_dwordx4 v[104:107], v240, s[16:19], s41 offen offset:2048
    v_mfma_f32_16x16x32_bf16 v[40:43], v[152:155], v[140:143], v[40:43]
    v_mfma_f32_16x16x32_bf16 v[44:47], v[152:155], v[144:147], v[44:47]
    buffer_load_dwordx4 v[108:111], v240, s[16:19], s41 offen offset:3072
    s_add_u32 s41, s41, 4096
    v_mfma_f32_16x16x32_bf16 v[48:51], v[156:159], v[132:135], v[48:51]
    v_mfma_f32_16x16x32_bf16 v[52:55], v[156:159], v[136:139], v[52:55]
    buffer_load_dwordx4 v[112:115], v240, s[16:19], s42 offen offset:0
    v_mfma_f32_16x16x32_bf16 v[56:59], v[156:159], v[140:143], v[56:59]
    v_mfma_f32_16x16x32_bf16 v[60:63], v[156:159], v[144:147], v[60:63]
    buffer_load_dwordx4 v[116:119], v240, s[16:19], s42 offen offset:1024
    v_mfma_f32_16x16x32_bf16 v[64:67], v[160:163], v[132:135], v[64:67]
    v_mfma_f32_16x16x32_bf16 v[68:71], v[160:163], v[136:139], v[68:71]
    buffer_load_dwordx4 v[120:123], v240, s[16:19], s42 offen offset:2048
    v_mfma_f32_16x16x32_bf16 v[72:75], v[160:163], v[140:143], v[72:75]
    v_mfma_f32_16x16x32_bf16 v[76:79], v[160:163], v[144:147], v[76:79]
    buffer_load_dwordx4 v[124:127], v240, s[16:19], s42 offen offset:3072
    v_mfma_f32_16x16x32_bf16 v[80:83], v[164:167], v[132:135], v[80:83]
    v_mfma_f32_16x16x32_bf16 v[84:87], v[164:167], v[136:139], v[84:87]
    buffer_load_dwordx4 v[128:131], v241, s[16:19], s42 offen
    s_add_u32 s42, s42, 40960
    v_mfma_f32_16x16x32_bf16 v[88:91], v[164:167], v[140:143], v[88:91]
    v_mfma_f32_16x16x32_bf16 v[92:95], v[164:167], v[144:147], v[92:95]
    s_waitcnt vmcnt(18)
    v_mfma_f32_16x16x32_bf16 v[16:19], v[184:187], v[168:171], v[16:19]
    v_mfma_f32_16x16x32_bf16 v[20:23], v[184:187], v[172:175], v[20:23]
    buffer_load_dwordx4 v[132:135], v240, s[16:19], s41 offen offset:0
    v_mfma_f32_16x16x32_bf16 v[24:27], v[184:187], v[176:179], v[24:27]
    v_mfma_f32_16x16x32_bf16 v[28:31], v[184:187], v[180:183], v[28:31]
    buffer_load_dwordx4 v[136:139], v240, s[16:19], s41 offen offset:1024
    v_mfma_f32_16x16x32_bf16 v[32:35], v[188:191], v[168:171], v[32:35]
    v_mfma_f32_16x16x32_bf16 v[36:39], v[188:191], v[172:175], v[36:39]
    buffer_load_dwordx4 v[140:143], v240, s[16:19], s41 offen offset:2048
    v_mfma_f32_16x16x32_bf16 v[40:43], v[188:191], v[176:179], v[40:43]
    v_mfma_f32_16x16x32_bf16 v[44:47], v[188:191], v[180:183], v[44:47]
    buffer_load_dwordx4 v[144:147], v240, s[16:19], s41 offen offset:3072
    s_add_u32 s41, s41, 4096
    v_mfma_f32_16x16x32_bf16 v[48:51], v[192:195], v[168:171], v[48:51]
    v_mfma_f32_16x16x32_bf16 v[52:55], v[192:195], v[172:175], v[52:55]
    buffer_load_dwordx4 v[148:151], v240, s[16:19], s42 offen offset:0
    v_mfma_f32_16x16x32_bf16 v[56:59], v[192:195], v[176:179], v[56:59]
    v_mfma_f32_16x16x32_bf16 v[60:63], v[192:195], v[180:183], v[60:63]
    buffer_load_dwordx4 v[152:155], v240, s[16:19], s42 offen offset:1024
    v_mfma_f32_16x16x32_bf16 v[64:67], v[196:199], v[168:171], v[64:67]
    v_mfma_f32_16x16x32_bf16 v[68:71], v[196:199], v[172:175], v[68:71]
    buffer_load_dwordx4 v[156:159], v240, s[16:19], s42 offen offset:2048
    v_mfma_f32_16x16x32_bf16 v[72:75], v[196:199], v[176:179], v[72:75]
    v_mfma_f32_16x16x32_bf16 v[76:79], v[196:199], v[180:183], v[76:79]
    buffer_load_dwordx4 v[160:163], v240, s[16:19], s42 offen offset:3072
    v_mfma_f32_16x16x32_bf16 v[80:83], v[200:203], v[168:171], v[80:83]
    v_mfma_f32_16x16x32_bf16 v[84:87], v[200:203], v[172:175], v[84:87]
    buffer_load_dwordx4 v[164:167], v241, s[16:19], s42 offen
    s_add_u32 s42, s42, 40960
    v_mfma_f32_16x16x32_bf16 v[88:91], v[200:203], v[176:179], v[88:91]
    v_mfma_f32_16x16x32_bf16 v[92:95], v[200:203], v[180:183], v[92:95]
    s_waitcnt vmcnt(18)
    v_mfma_f32_16x16x32_bf16 v[16:19], v[220:223], v[204:207], v[16:19]
    v_mfma_f32_16x16x32_bf16 v[20:23], v[220:223], v[208:211], v[20:23]
    buffer_load_dwordx4 v[168:171], v240, s[16:19], s41 offen offset:0
    v_mfma_f32_16x16x32_bf16 v[24:27], v[220:223], v[212:215], v[24:27]
    v_mfma_f32_16x16x32_bf16 v[28:31], v[220:223], v[216:219], v[28:31]
    buffer_load_dwordx4 v[172:175], v240, s[16:19], s41 offen offset:1024
    v_mfma_f32_16x16x32_bf16 v[32:35], v[224:227], v[204:207], v[32:35]
    v_mfma_f32_16x16x32_bf16 v[36:39], v[224:227], v[208:211], v[36:39]
    buffer_load_dwordx4 v[176:179], v240, s[16:19], s41 offen offset:2048
    v_mfma_f32_16x16x32_bf16 v[40:43], v[224:227], v[212:215], v[40:43]
    v_mfma_f32_16x16x32_bf16 v[44:47], v[224:227], v[216:219], v[44:47]
    buffer_load_dwordx4 v[180:183], v240, s[16:19], s41 offen offset:3072
    s_add_u32 s41, s41, 4096
    v_mfma_f32_16x16x32_bf16 v[48:51], v[228:231], v[204:207], v[48:51]
    v_mfma_f32_16x16x32_bf16 v[52:55], v[228:231], v[208:211], v[52:55]
    buffer_load_dwordx4 v[184:187], v240, s[16:19], s42 offen offset:0
    v_mfma_f32_16x16x32_bf16 v[56:59], v[228:231], v[212:215], v[56:59]
    v_mfma_f32_16x16x32_bf16 v[60:63], v[228:231], v[216:219], v[60:63]
    buffer_load_dwordx4 v[188:191], v240, s[16:19], s42 offen offset:1024
    v_mfma_f32_16x16x32_bf16 v[64:67], v[232:235], v[204:207], v[64:67]
    v_mfma_f32_16x16x32_bf16 v[68:71], v[232:235], v[208:211], v[68:71]
    buffer_load_dwordx4 v[192:195], v240, s[16:19], s42 offen offset:2048
    v_mfma_f32_16x16x32_bf16 v[72:75], v[232:235], v[212:215], v[72:75]
    v_mfma_f32_16x16x32_bf16 v[76:79], v[232:235], v[216:219], v[76:79]
    buffer_load_dwordx4 v[196:199], v240, s[16:19], s42 offen offset:3072
    v_mfma_f32_16x16x32_bf16 v[80:83], v[236:239], v[204:207], v[80:83]
    v_mfma_f32_16x16x32_bf16 v[84:87], v[236:239], v[208:211], v[84:87]
    buffer_load_dwordx4 v[200:203], v241, s[16:19], s42 offen
    s_add_u32 s42, s42, 40960
    v_mfma_f32_16x16x32_bf16 v[88:91], v[236:239], v[212:215], v[88:91]
    v_mfma_f32_16x16x32_bf16 v[92:95], v[236:239], v[216:219], v[92:95]
    s_waitcnt vmcnt(18)
    v_mfma_f32_16x16x32_bf16 v[16:19], v[112:115], v[96:99], v[16:19]
    v_mfma_f32_16x16x32_bf16 v[20:23], v[112:115], v[100:103], v[20:23]
    buffer_load_dwordx4 v[204:207], v240, s[16:19], s41 offen offset:0
    v_mfma_f32_16x16x32_bf16 v[24:27], v[112:115], v[104:107], v[24:27]
    v_mfma_f32_16x16x32_bf16 v[28:31], v[112:115], v[108:111], v[28:31]
    buffer_load_dwordx4 v[208:211], v240, s[16:19], s41 offen offset:1024
    v_mfma_f32_16x16x32_bf16 v[32:35], v[116:119], v[96:99], v[32:35]
    v_mfma_f32_16x16x32_bf16 v[36:39], v[116:119], v[100:103], v[36:39]
    buffer_load_dwordx4 v[212:215], v240, s[16:19], s41 offen offset:2048
    v_mfma_f32_16x16x32_bf16 v[40:43], v[116:119], v[104:107], v[40:43]
    v_mfma_f32_16x16x32_bf16 v[44:47], v[116:119], v[108:111], v[44:47]
    buffer_load_dwordx4 v[216:219], v240, s[16:19], s41 offen offset:3072
    s_add_u32 s41, s41, 4096
    v_mfma_f32_16x16x32_bf16 v[48:51], v[120:123], v[96:99], v[48:51]
    v_mfma_f32_16x16x32_bf16 v[52:55], v[120:123], v[100:103], v[52:55]
    buffer_load_dwordx4 v[220:223], v240, s[16:19], s42 offen offset:0
    v_mfma_f32_16x16x32_bf16 v[56:59], v[120:123], v[104:107], v[56:59]
    v_mfma_f32_16x16x32_bf16 v[60:63], v[120:123], v[108:111], v[60:63]
    buffer_load_dwordx4 v[224:227], v240, s[16:19], s42 offen offset:1024
    v_mfma_f32_16x16x32_bf16 v[64:67], v[124:127], v[96:99], v[64:67]
    v_mfma_f32_16x16x32_bf16 v[68:71], v[124:127], v[100:103], v[68:71]
    buffer_load_dwordx4 v[228:231], v240, s[16:19], s42 offen offset:2048
    v_mfma_f32_16x16x32_bf16 v[72:75], v[124:127], v[104:107], v[72:75]
    v_mfma_f32_16x16x32_bf16 v[76:79], v[124:127], v[108:111], v[76:79]
    buffer_load_dwordx4 v[232:235], v240, s[16:19], s42 offen offset:3072
    v_mfma_f32_16x16x32_bf16 v[80:83], v[128:131], v[96:99], v[80:83]
    v_mfma_f32_16x16x32_bf16 v[84:87], v[128:131], v[100:103], v[84:87]
    buffer_load_dwordx4 v[236:239], v241, s[16:19], s42 offen
    s_add_u32 s42, s42, 40960
    v_mfma_f32_16x16x32_bf16 v[88:91], v[128:131], v[104:107], v[88:91]
    v_mfma_f32_16x16x32_bf16 v[92:95], v[128:131], v[108:111], v[92:95]
    s_mul_i32 s42, s33, 240
    s_add_u32 s42, s42, s43
    s_lshl_b32 s42, s42, 10
    s_add_u32 s42, s42, 20840448
    s_waitcnt vmcnt(18)
    v_mfma_f32_16x16x32_bf16 v[16:19], v[148:151], v[132:135], v[16:19]
    v_mfma_f32_16x16x32_bf16 v[20:23], v[148:151], v[136:139], v[20:23]
    buffer_load_dwordx4 v[112:115], v240, s[16:19], s42 offen offset:0
    v_mfma_f32_16x16x32_bf16 v[24:27], v[148:151], v[140:143], v[24:27]
    v_mfma_f32_16x16x32_bf16 v[28:31], v[148:151], v[144:147], v[28:31]
    buffer_load_dwordx4 v[116:119], v240, s[16:19], s42 offen offset:1024
    v_mfma_f32_16x16x32_bf16 v[32:35], v[152:155], v[132:135], v[32:35]
    v_mfma_f32_16x16x32_bf16 v[36:39], v[152:155], v[136:139], v[36:39]
    buffer_load_dwordx4 v[120:123], v240, s[16:19], s42 offen offset:2048
    v_mfma_f32_16x16x32_bf16 v[40:43], v[152:155], v[140:143], v[40:43]
    v_mfma_f32_16x16x32_bf16 v[44:47], v[152:155], v[144:147], v[44:47]
    buffer_load_dwordx4 v[124:127], v240, s[16:19], s42 offen offset:3072
    v_mfma_f32_16x16x32_bf16 v[48:51], v[156:159], v[132:135], v[48:51]
    v_mfma_f32_16x16x32_bf16 v[52:55], v[156:159], v[136:139], v[52:55]
    buffer_load_dwordx4 v[128:131], v241, s[16:19], s42 offen
    s_add_u32 s42, s42, 40960
    v_mfma_f32_16x16x32_bf16 v[56:59], v[156:159], v[140:143], v[56:59]
    v_mfma_f32_16x16x32_bf16 v[60:63], v[156:159], v[144:147], v[60:63]
    v_mfma_f32_16x16x32_bf16 v[64:67], v[160:163], v[132:135], v[64:67]
    v_mfma_f32_16x16x32_bf16 v[68:71], v[160:163], v[136:139], v[68:71]
    v_mfma_f32_16x16x32_bf16 v[72:75], v[160:163], v[140:143], v[72:75]
    v_mfma_f32_16x16x32_bf16 v[76:79], v[160:163], v[144:147], v[76:79]
    v_mfma_f32_16x16x32_bf16 v[80:83], v[164:167], v[132:135], v[80:83]
    v_mfma_f32_16x16x32_bf16 v[84:87], v[164:167], v[136:139], v[84:87]
    v_mfma_f32_16x16x32_bf16 v[88:91], v[164:167], v[140:143], v[88:91]
    v_mfma_f32_16x16x32_bf16 v[92:95], v[164:167], v[144:147], v[92:95]
    s_waitcnt vmcnt(14)
    v_mfma_f32_16x16x32_bf16 v[16:19], v[184:187], v[168:171], v[16:19]
    v_mfma_f32_16x16x32_bf16 v[20:23], v[184:187], v[172:175], v[20:23]
    buffer_load_dwordx4 v[148:151], v240, s[16:19], s42 offen offset:0
    v_mfma_f32_16x16x32_bf16 v[24:27], v[184:187], v[176:179], v[24:27]
    v_mfma_f32_16x16x32_bf16 v[28:31], v[184:187], v[180:183], v[28:31]
    buffer_load_dwordx4 v[152:155], v240, s[16:19], s42 offen offset:1024
    v_mfma_f32_16x16x32_bf16 v[32:35], v[188:191], v[168:171], v[32:35]
    v_mfma_f32_16x16x32_bf16 v[36:39], v[188:191], v[172:175], v[36:39]
    buffer_load_dwordx4 v[156:159], v240, s[16:19], s42 offen offset:2048
    v_mfma_f32_16x16x32_bf16 v[40:43], v[188:191], v[176:179], v[40:43]
    v_mfma_f32_16x16x32_bf16 v[44:47], v[188:191], v[180:183], v[44:47]
    buffer_load_dwordx4 v[160:163], v240, s[16:19], s42 offen offset:3072
    v_mfma_f32_16x16x32_bf16 v[48:51], v[192:195], v[168:171], v[48:51]
    v_mfma_f32_16x16x32_bf16 v[52:55], v[192:195], v[172:175], v[52:55]
    buffer_load_dwordx4 v[164:167], v241, s[16:19], s42 offen
    s_add_u32 s42, s42, 40960
    v_mfma_f32_16x16x32_bf16 v[56:59], v[192:195], v[176:179], v[56:59]
    v_mfma_f32_16x16x32_bf16 v[60:63], v[192:195], v[180:183], v[60:63]
    v_mfma_f32_16x16x32_bf16 v[64:67], v[196:199], v[168:171], v[64:67]
    v_mfma_f32_16x16x32_bf16 v[68:71], v[196:199], v[172:175], v[68:71]
    v_mfma_f32_16x16x32_bf16 v[72:75], v[196:199], v[176:179], v[72:75]
    v_mfma_f32_16x16x32_bf16 v[76:79], v[196:199], v[180:183], v[76:79]
    v_mfma_f32_16x16x32_bf16 v[80:83], v[200:203], v[168:171], v[80:83]
    v_mfma_f32_16x16x32_bf16 v[84:87], v[200:203], v[172:175], v[84:87]
    v_mfma_f32_16x16x32_bf16 v[88:91], v[200:203], v[176:179], v[88:91]
    v_mfma_f32_16x16x32_bf16 v[92:95], v[200:203], v[180:183], v[92:95]
    s_waitcnt vmcnt(10)
    v_mfma_f32_16x16x32_bf16 v[16:19], v[220:223], v[204:207], v[16:19]
    v_mfma_f32_16x16x32_bf16 v[20:23], v[220:223], v[208:211], v[20:23]
    buffer_load_dwordx4 v[184:187], v240, s[16:19], s42 offen offset:0
    v_mfma_f32_16x16x32_bf16 v[24:27], v[220:223], v[212:215], v[24:27]
    v_mfma_f32_16x16x32_bf16 v[28:31], v[220:223], v[216:219], v[28:31]
    buffer_load_dwordx4 v[188:191], v240, s[16:19], s42 offen offset:1024
    v_mfma_f32_16x16x32_bf16 v[32:35], v[224:227], v[204:207], v[32:35]
    v_mfma_f32_16x16x32_bf16 v[36:39], v[224:227], v[208:211], v[36:39]
    buffer_load_dwordx4 v[192:195], v240, s[16:19], s42 offen offset:2048
    v_mfma_f32_16x16x32_bf16 v[40:43], v[224:227], v[212:215], v[40:43]
    v_mfma_f32_16x16x32_bf16 v[44:47], v[224:227], v[216:219], v[44:47]
    buffer_load_dwordx4 v[196:199], v240, s[16:19], s42 offen offset:3072
    v_mfma_f32_16x16x32_bf16 v[48:51], v[228:231], v[204:207], v[48:51]
    v_mfma_f32_16x16x32_bf16 v[52:55], v[228:231], v[208:211], v[52:55]
    buffer_load_dwordx4 v[200:203], v241, s[16:19], s42 offen
    s_add_u32 s42, s42, 40960
    v_mfma_f32_16x16x32_bf16 v[56:59], v[228:231], v[212:215], v[56:59]
    v_mfma_f32_16x16x32_bf16 v[60:63], v[228:231], v[216:219], v[60:63]
    v_mfma_f32_16x16x32_bf16 v[64:67], v[232:235], v[204:207], v[64:67]
    v_mfma_f32_16x16x32_bf16 v[68:71], v[232:235], v[208:211], v[68:71]
    v_mfma_f32_16x16x32_bf16 v[72:75], v[232:235], v[212:215], v[72:75]
    v_mfma_f32_16x16x32_bf16 v[76:79], v[232:235], v[216:219], v[76:79]
    v_mfma_f32_16x16x32_bf16 v[80:83], v[236:239], v[204:207], v[80:83]
    v_mfma_f32_16x16x32_bf16 v[84:87], v[236:239], v[208:211], v[84:87]
    v_mfma_f32_16x16x32_bf16 v[88:91], v[236:239], v[212:215], v[88:91]
    v_mfma_f32_16x16x32_bf16 v[92:95], v[236:239], v[216:219], v[92:95]
    buffer_load_dwordx4 v[220:223], v240, s[16:19], s42 offen offset:0
    buffer_load_dwordx4 v[224:227], v240, s[16:19], s42 offen offset:1024
    buffer_load_dwordx4 v[228:231], v240, s[16:19], s42 offen offset:2048
    buffer_load_dwordx4 v[232:235], v240, s[16:19], s42 offen offset:3072
    buffer_load_dwordx4 v[236:239], v241, s[16:19], s42 offen
    s_add_u32 s42, s42, 40960
    v_sub_f32 v12, 1.0, v12
    v_sub_f32 v13, 1.0, v13
    v_sub_f32 v14, 1.0, v14
    v_sub_f32 v15, 1.0, v15
    s_lshl_b32 s45, s34, 5
    s_lshl_b32 s46, s33, 3
    s_add_u32 s45, s45, s46
    s_lshl_b32 s45, s45, 2
    s_add_u32 s45, s45, 21831680
    s_mul_i32 s41, s34, 24
    s_mul_i32 s44, s33, 6
    s_add_u32 s41, s41, s44
    s_lshl_b32 s41, s41, 12
    s_add_u32 s41, s41, 15728640
    s_nop 2
    v_mul_f32 v16, v16, v12
    v_mul_f32 v17, v17, v12
    v_mul_f32 v18, v18, v12
    v_mul_f32 v19, v19, v12
    v_mul_f32 v20, v20, v13
    v_mul_f32 v21, v21, v13
    v_mul_f32 v22, v22, v13
    v_mul_f32 v23, v23, v13
    v_mul_f32 v24, v24, v14
    v_mul_f32 v25, v25, v14
    v_mul_f32 v26, v26, v14
    v_mul_f32 v27, v27, v14
    v_mul_f32 v28, v28, v15
    v_mul_f32 v29, v29, v15
    v_mul_f32 v30, v30, v15
    v_mul_f32 v31, v31, v15
    v_mul_f32 v32, v32, v12
    v_mul_f32 v33, v33, v12
    v_mul_f32 v34, v34, v12
    v_mul_f32 v35, v35, v12
    v_mul_f32 v36, v36, v13
    v_mul_f32 v37, v37, v13
    v_mul_f32 v38, v38, v13
    v_mul_f32 v39, v39, v13
    v_mul_f32 v40, v40, v14
    v_mul_f32 v41, v41, v14
    v_mul_f32 v42, v42, v14
    v_mul_f32 v43, v43, v14
    v_mul_f32 v44, v44, v15
    v_mul_f32 v45, v45, v15
    v_mul_f32 v46, v46, v15
    v_mul_f32 v47, v47, v15
    v_mul_f32 v48, v48, v12
    v_mul_f32 v49, v49, v12
    v_mul_f32 v50, v50, v12
    v_mul_f32 v51, v51, v12
    v_mul_f32 v52, v52, v13
    v_mul_f32 v53, v53, v13
    v_mul_f32 v54, v54, v13
    v_mul_f32 v55, v55, v13
    v_mul_f32 v56, v56, v14
    v_mul_f32 v57, v57, v14
    v_mul_f32 v58, v58, v14
    v_mul_f32 v59, v59, v14
    v_mul_f32 v60, v60, v15
    v_mul_f32 v61, v61, v15
    v_mul_f32 v62, v62, v15
    v_mul_f32 v63, v63, v15
    v_mul_f32 v64, v64, v12
    v_mul_f32 v65, v65, v12
    v_mul_f32 v66, v66, v12
    v_mul_f32 v67, v67, v12
    v_mul_f32 v68, v68, v13
    v_mul_f32 v69, v69, v13
    v_mul_f32 v70, v70, v13
    v_mul_f32 v71, v71, v13
    v_mul_f32 v72, v72, v14
    v_mul_f32 v73, v73, v14
    v_mul_f32 v74, v74, v14
    v_mul_f32 v75, v75, v14
    v_mul_f32 v76, v76, v15
    v_mul_f32 v77, v77, v15
    v_mul_f32 v78, v78, v15
    v_mul_f32 v79, v79, v15
    v_mul_f32 v80, v80, v12
    v_mul_f32 v81, v81, v12
    v_mul_f32 v82, v82, v12
    v_mul_f32 v83, v83, v12
    v_mul_f32 v84, v84, v13
    v_mul_f32 v85, v85, v13
    v_mul_f32 v86, v86, v13
    v_mul_f32 v87, v87, v13
    v_mul_f32 v88, v88, v14
    v_mul_f32 v89, v89, v14
    v_mul_f32 v90, v90, v14
    v_mul_f32 v91, v91, v14
    v_mul_f32 v92, v92, v15
    v_mul_f32 v93, v93, v15
    v_mul_f32 v94, v94, v15
    v_mul_f32 v95, v95, v15
    v_lshlrev_b32 v3, 4, v0
    v_mov_b32 v8, 0x80000000
    v_cmp_gt_u32 vcc, 2, v0
    s_nop 1
    v_cndmask_b32 v3, v8, v3, vcc
    s_mov_b64 s[56:57], vcc
K2_s2:
    buffer_load_dwordx4 v[4:7], v3, s[16:19], s45 offen sc1
    s_waitcnt vmcnt(0)
    v_xor_b32 v4, s97, v4
    v_xor_b32 v5, s97, v5
    v_xor_b32 v6, s97, v6
    v_xor_b32 v7, s97, v7
    v_or3_b32 v4, v4, v5, v6
    v_or_b32 v4, v4, v7
    v_cmp_ne_u32 vcc, 0, v4
    s_nop 0
    s_and_b64 vcc, vcc, s[56:57]
    s_cbranch_vccz K2_s2_ok
    s_sleep 1
    s_branch K2_s2
K2_s2_ok:
    buffer_load_dwordx4 v[96:99], v240, s[16:19], s41 offen offset:0 sc1
    buffer_load_dwordx4 v[100:103], v240, s[16:19], s41 offen offset:1024 sc1
    buffer_load_dwordx4 v[104:107], v240, s[16:19], s41 offen offset:2048 sc1
    buffer_load_dwordx4 v[108:111], v240, s[16:19], s41 offen offset:3072 sc1
    s_add_u32 s41, s41, 4096
    buffer_load_dwordx4 v[132:135], v240, s[16:19], s41 offen offset:0 sc1
    buffer_load_dwordx4 v[136:139], v240, s[16:19], s41 offen offset:1024 sc1
    buffer_load_dwordx4 v[140:143], v240, s[16:19], s41 offen offset:2048 sc1
    buffer_load_dwordx4 v[144:147], v240, s[16:19], s41 offen offset:3072 sc1
    s_add_u32 s41, s41, 4096
    buffer_load_dwordx4 v[168:171], v240, s[16:19], s41 offen offset:0 sc1
    buffer_load_dwordx4 v[172:175], v240, s[16:19], s41 offen offset:1024 sc1
    buffer_load_dwordx4 v[176:179], v240, s[16:19], s41 offen offset:2048 sc1
    buffer_load_dwordx4 v[180:183], v240, s[16:19], s41 offen offset:3072 sc1
    s_add_u32 s41, s41, 4096
    buffer_load_dwordx4 v[204:207], v240, s[16:19], s41 offen offset:0 sc1
    buffer_load_dwordx4 v[208:211], v240, s[16:19], s41 offen offset:1024 sc1
    buffer_load_dwordx4 v[212:215], v240, s[16:19], s41 offen offset:2048 sc1
    buffer_load_dwordx4 v[216:219], v240, s[16:19], s41 offen offset:3072 sc1
    s_add_u32 s41, s41, 4096
    s_waitcnt vmcnt(12)
    v_mfma_f32_16x16x32_bf16 v[16:19], v[112:115], v[96:99], v[16:19]
    v_mfma_f32_16x16x32_bf16 v[20:23], v[112:115], v[100:103], v[20:23]
    v_mfma_f32_16x16x32_bf16 v[24:27], v[112:115], v[104:107], v[24:27]
    v_mfma_f32_16x16x32_bf16 v[28:31], v[112:115], v[108:111], v[28:31]
    v_mfma_f32_16x16x32_bf16 v[32:35], v[116:119], v[96:99], v[32:35]
    v_mfma_f32_16x16x32_bf16 v[36:39], v[116:119], v[100:103], v[36:39]
    v_mfma_f32_16x16x32_bf16 v[40:43], v[116:119], v[104:107], v[40:43]
    v_mfma_f32_16x16x32_bf16 v[44:47], v[116:119], v[108:111], v[44:47]
    v_mfma_f32_16x16x32_bf16 v[48:51], v[120:123], v[96:99], v[48:51]
    v_mfma_f32_16x16x32_bf16 v[52:55], v[120:123], v[100:103], v[52:55]
    v_mfma_f32_16x16x32_bf16 v[56:59], v[120:123], v[104:107], v[56:59]
    v_mfma_f32_16x16x32_bf16 v[60:63], v[120:123], v[108:111], v[60:63]
    v_mfma_f32_16x16x32_bf16 v[64:67], v[124:127], v[96:99], v[64:67]
    v_mfma_f32_16x16x32_bf16 v[68:71], v[124:127], v[100:103], v[68:71]
    v_mfma_f32_16x16x32_bf16 v[72:75], v[124:127], v[104:107], v[72:75]
    v_mfma_f32_16x16x32_bf16 v[76:79], v[124:127], v[108:111], v[76:79]
    v_mfma_f32_16x16x32_bf16 v[80:83], v[128:131], v[96:99], v[80:83]
    v_mfma_f32_16x16x32_bf16 v[84:87], v[128:131], v[100:103], v[84:87]
    v_mfma_f32_16x16x32_bf16 v[88:91], v[128:131], v[104:107], v[88:91]
    v_mfma_f32_16x16x32_bf16 v[92:95], v[128:131], v[108:111], v[92:95]
    s_waitcnt vmcnt(8)
    v_mfma_f32_16x16x32_bf16 v[16:19], v[148:151], v[132:135], v[16:19]
    v_mfma_f32_16x16x32_bf16 v[20:23], v[148:151], v[136:139], v[20:23]
    buffer_load_dwordx4 v[96:99], v240, s[16:19], s41 offen offset:0 sc1
    v_mfma_f32_16x16x32_bf16 v[24:27], v[148:151], v[140:143], v[24:27]
    v_mfma_f32_16x16x32_bf16 v[28:31], v[148:151], v[144:147], v[28:31]
    buffer_load_dwordx4 v[100:103], v240, s[16:19], s41 offen offset:1024 sc1
    v_mfma_f32_16x16x32_bf16 v[32:35], v[152:155], v[132:135], v[32:35]
    v_mfma_f32_16x16x32_bf16 v[36:39], v[152:155], v[136:139], v[36:39]
    buffer_load_dwordx4 v[104:107], v240, s[16:19], s41 offen offset:2048 sc1
    v_mfma_f32_16x16x32_bf16 v[40:43], v[152:155], v[140:143], v[40:43]
    v_mfma_f32_16x16x32_bf16 v[44:47], v[152:155], v[144:147], v[44:47]
    buffer_load_dwordx4 v[108:111], v240, s[16:19], s41 offen offset:3072 sc1
    s_add_u32 s41, s41, 4096
    v_mfma_f32_16x16x32_bf16 v[48:51], v[156:159], v[132:135], v[48:51]
    v_mfma_f32_16x16x32_bf16 v[52:55], v[156:159], v[136:139], v[52:55]
    buffer_load_dwordx4 v[112:115], v240, s[16:19], s42 offen offset:0
    v_mfma_f32_16x16x32_bf16 v[56:59], v[156:159], v[140:143], v[56:59]
    v_mfma_f32_16x16x32_bf16 v[60:63], v[156:159], v[144:147], v[60:63]
    buffer_load_dwordx4 v[116:119], v240, s[16:19], s42 offen offset:1024
    v_mfma_f32_16x16x32_bf16 v[64:67], v[160:163], v[132:135], v[64:67]
    v_mfma_f32_16x16x32_bf16 v[68:71], v[160:163], v[136:139], v[68:71]
    buffer_load_dwordx4 v[120:123], v240, s[16:19], s42 offen offset:2048
    v_mfma_f32_16x16x32_bf16 v[72:75], v[160:163], v[140:143], v[72:75]
    v_mfma_f32_16x16x32_bf16 v[76:79], v[160:163], v[144:147], v[76:79]
    buffer_load_dwordx4 v[124:127], v240, s[16:19], s42 offen offset:3072
    v_mfma_f32_16x16x32_bf16 v[80:83], v[164:167], v[132:135], v[80:83]
    v_mfma_f32_16x16x32_bf16 v[84:87], v[164:167], v[136:139], v[84:87]
    buffer_load_dwordx4 v[128:131], v241, s[16:19], s42 offen
    s_add_u32 s42, s42, 40960
    v_mfma_f32_16x16x32_bf16 v[88:91], v[164:167], v[140:143], v[88:91]
    v_mfma_f32_16x16x32_bf16 v[92:95], v[164:167], v[144:147], v[92:95]
    s_waitcnt vmcnt(13)
    v_mfma_f32_16x16x32_bf16 v[16:19], v[184:187], v[168:171], v[16:19]
    v_mfma_f32_16x16x32_bf16 v[20:23], v[184:187], v[172:175], v[20:23]
    buffer_load_dwordx4 v[132:135], v240, s[16:19], s41 offen offset:0 sc1
    v_mfma_f32_16x16x32_bf16 v[24:27], v[184:187], v[176:179], v[24:27]
    v_mfma_f32_16x16x32_bf16 v[28:31], v[184:187], v[180:183], v[28:31]
    buffer_load_dwordx4 v[136:139], v240, s[16:19], s41 offen offset:1024 sc1
    v_mfma_f32_16x16x32_bf16 v[32:35], v[188:191], v[168:171], v[32:35]
    v_mfma_f32_16x16x32_bf16 v[36:39], v[188:191], v[172:175], v[36:39]
    buffer_load_dwordx4 v[140:143], v240, s[16:19], s41 offen offset:2048 sc1
    v_mfma_f32_16x16x32_bf16 v[40:43], v[188:191], v[176:179], v[40:43]
    v_mfma_f32_16x16x32_bf16 v[44:47], v[188:191], v[180:183], v[44:47]
    buffer_load_dwordx4 v[144:147], v240, s[16:19], s41 offen offset:3072 sc1
    s_add_u32 s41, s41, 4096
    v_mfma_f32_16x16x32_bf16 v[48:51], v[192:195], v[168:171], v[48:51]
    v_mfma_f32_16x16x32_bf16 v[52:55], v[192:195], v[172:175], v[52:55]
    buffer_load_dwordx4 v[148:151], v240, s[16:19], s42 offen offset:0
    v_mfma_f32_16x16x32_bf16 v[56:59], v[192:195], v[176:179], v[56:59]
    v_mfma_f32_16x16x32_bf16 v[60:63], v[192:195], v[180:183], v[60:63]
    buffer_load_dwordx4 v[152:155], v240, s[16:19], s42 offen offset:1024
    v_mfma_f32_16x16x32_bf16 v[64:67], v[196:199], v[168:171], v[64:67]
    v_mfma_f32_16x16x32_bf16 v[68:71], v[196:199], v[172:175], v[68:71]
    buffer_load_dwordx4 v[156:159], v240, s[16:19], s42 offen offset:2048
    v_mfma_f32_16x16x32_bf16 v[72:75], v[196:199], v[176:179], v[72:75]
    v_mfma_f32_16x16x32_bf16 v[76:79], v[196:199], v[180:183], v[76:79]
    buffer_load_dwordx4 v[160:163], v240, s[16:19], s42 offen offset:3072
    v_mfma_f32_16x16x32_bf16 v[80:83], v[200:203], v[168:171], v[80:83]
    v_mfma_f32_16x16x32_bf16 v[84:87], v[200:203], v[172:175], v[84:87]
    buffer_load_dwordx4 v[164:167], v241, s[16:19], s42 offen
    s_add_u32 s42, s42, 40960
    v_mfma_f32_16x16x32_bf16 v[88:91], v[200:203], v[176:179], v[88:91]
    v_mfma_f32_16x16x32_bf16 v[92:95], v[200:203], v[180:183], v[92:95]
    s_waitcnt vmcnt(18)
    v_mfma_f32_16x16x32_bf16 v[16:19], v[220:223], v[204:207], v[16:19]
    v_mfma_f32_16x16x32_bf16 v[20:23], v[220:223], v[208:211], v[20:23]
    v_mfma_f32_16x16x32_bf16 v[24:27], v[220:223], v[212:215], v[24:27]
    v_mfma_f32_16x16x32_bf16 v[28:31], v[220:223], v[216:219], v[28:31]
    v_mfma_f32_16x16x32_bf16 v[32:35], v[224:227], v[204:207], v[32:35]
    v_mfma_f32_16x16x32_bf16 v[36:39], v[224:227], v[208:211], v[36:39]
    v_mfma_f32_16x16x32_bf16 v[40:43], v[224:227], v[212:215], v[40:43]
    v_mfma_f32_16x16x32_bf16 v[44:47], v[224:227], v[216:219], v[44:47]
    v_mfma_f32_16x16x32_bf16 v[48:51], v[228:231], v[204:207], v[48:51]
    v_mfma_f32_16x16x32_bf16 v[52:55], v[228:231], v[208:211], v[52:55]
    v_mfma_f32_16x16x32_bf16 v[56:59], v[228:231], v[212:215], v[56:59]
    v_mfma_f32_16x16x32_bf16 v[60:63], v[228:231], v[216:219], v[60:63]
    v_mfma_f32_16x16x32_bf16 v[64:67], v[232:235], v[204:207], v[64:67]
    v_mfma_f32_16x16x32_bf16 v[68:71], v[232:235], v[208:211], v[68:71]
    v_mfma_f32_16x16x32_bf16 v[72:75], v[232:235], v[212:215], v[72:75]
    v_mfma_f32_16x16x32_bf16 v[76:79], v[232:235], v[216:219], v[76:79]
    v_mfma_f32_16x16x32_bf16 v[80:83], v[236:239], v[204:207], v[80:83]
    v_mfma_f32_16x16x32_bf16 v[84:87], v[236:239], v[208:211], v[84:87]
    v_mfma_f32_16x16x32_bf16 v[88:91], v[236:239], v[212:215], v[88:91]
    v_mfma_f32_16x16x32_bf16 v[92:95], v[236:239], v[216:219], v[92:95]
    s_waitcnt vmcnt(9)
    v_mfma_f32_16x16x32_bf16 v[16:19], v[112:115], v[96:99], v[16:19]
    v_mfma_f32_16x16x32_bf16 v[20:23], v[112:115], v[100:103], v[20:23]
    v_mfma_f32_16x16x32_bf16 v[24:27], v[112:115], v[104:107], v[24:27]
    v_mfma_f32_16x16x32_bf16 v[28:31], v[112:115], v[108:111], v[28:31]
    v_mfma_f32_16x16x32_bf16 v[32:35], v[116:119], v[96:99], v[32:35]
    v_mfma_f32_16x16x32_bf16 v[36:39], v[116:119], v[100:103], v[36:39]
    v_mfma_f32_16x16x32_bf16 v[40:43], v[116:119], v[104:107], v[40:43]
    v_mfma_f32_16x16x32_bf16 v[44:47], v[116:119], v[108:111], v[44:47]
    v_mfma_f32_16x16x32_bf16 v[48:51], v[120:123], v[96:99], v[48:51]
    v_mfma_f32_16x16x32_bf16 v[52:55], v[120:123], v[100:103], v[52:55]
    v_mfma_f32_16x16x32_bf16 v[56:59], v[120:123], v[104:107], v[56:59]
    v_mfma_f32_16x16x32_bf16 v[60:63], v[120:123], v[108:111], v[60:63]
    v_mfma_f32_16x16x32_bf16 v[64:67], v[124:127], v[96:99], v[64:67]
    v_mfma_f32_16x16x32_bf16 v[68:71], v[124:127], v[100:103], v[68:71]
    v_mfma_f32_16x16x32_bf16 v[72:75], v[124:127], v[104:107], v[72:75]
    v_mfma_f32_16x16x32_bf16 v[76:79], v[124:127], v[108:111], v[76:79]
    v_mfma_f32_16x16x32_bf16 v[80:83], v[128:131], v[96:99], v[80:83]
    v_mfma_f32_16x16x32_bf16 v[84:87], v[128:131], v[100:103], v[84:87]
    v_mfma_f32_16x16x32_bf16 v[88:91], v[128:131], v[104:107], v[88:91]
    v_mfma_f32_16x16x32_bf16 v[92:95], v[128:131], v[108:111], v[92:95]
    s_waitcnt vmcnt(0)
    v_mfma_f32_16x16x32_bf16 v[16:19], v[148:151], v[132:135], v[16:19]
    v_mfma_f32_16x16x32_bf16 v[20:23], v[148:151], v[136:139], v[20:23]
    v_mfma_f32_16x16x32_bf16 v[24:27], v[148:151], v[140:143], v[24:27]
    v_mfma_f32_16x16x32_bf16 v[28:31], v[148:151], v[144:147], v[28:31]
    v_mfma_f32_16x16x32_bf16 v[32:35], v[152:155], v[132:135], v[32:35]
    v_mfma_f32_16x16x32_bf16 v[36:39], v[152:155], v[136:139], v[36:39]
    v_mfma_f32_16x16x32_bf16 v[40:43], v[152:155], v[140:143], v[40:43]
    v_mfma_f32_16x16x32_bf16 v[44:47], v[152:155], v[144:147], v[44:47]
    v_mfma_f32_16x16x32_bf16 v[48:51], v[156:159], v[132:135], v[48:51]
    v_mfma_f32_16x16x32_bf16 v[52:55], v[156:159], v[136:139], v[52:55]
    v_mfma_f32_16x16x32_bf16 v[56:59], v[156:159], v[140:143], v[56:59]
    v_mfma_f32_16x16x32_bf16 v[60:63], v[156:159], v[144:147], v[60:63]
    v_mfma_f32_16x16x32_bf16 v[64:67], v[160:163], v[132:135], v[64:67]
    v_mfma_f32_16x16x32_bf16 v[68:71], v[160:163], v[136:139], v[68:71]
    v_mfma_f32_16x16x32_bf16 v[72:75], v[160:163], v[140:143], v[72:75]
    v_mfma_f32_16x16x32_bf16 v[76:79], v[160:163], v[144:147], v[76:79]
    v_mfma_f32_16x16x32_bf16 v[80:83], v[164:167], v[132:135], v[80:83]
    v_mfma_f32_16x16x32_bf16 v[84:87], v[164:167], v[136:139], v[84:87]
    v_mfma_f32_16x16x32_bf16 v[88:91], v[164:167], v[140:143], v[88:91]
    v_mfma_f32_16x16x32_bf16 v[92:95], v[164:167], v[144:147], v[92:95]
    s_mul_i32 s39, s33, 20480
    s_add_u32 s39, s39, 46592
    v_add_u32 v4, s39, v240
    s_nop 7
    s_cmp_eq_u32 s33, 0
    s_cbranch_scc1 K2_skipw0
    ds_write_b128 v4, v[16:19] offset:0
    ds_write_b128 v4, v[32:35] offset:1024
    ds_write_b128 v4, v[48:51] offset:2048
    ds_write_b128 v4, v[64:67] offset:3072
    ds_write_b128 v4, v[80:83] offset:4096
    s_branch K2_donew0
K2_skipw0:
    v_mov_b32 v156, v16
    v_mov_b32 v157, v17
    v_mov_b32 v158, v18
    v_mov_b32 v159, v19
    v_mov_b32 v160, v32
    v_mov_b32 v161, v33
    v_mov_b32 v162, v34
    v_mov_b32 v163, v35
    v_mov_b32 v164, v48
    v_mov_b32 v165, v49
    v_mov_b32 v166, v50
    v_mov_b32 v167, v51
    v_mov_b32 v168, v64
    v_mov_b32 v169, v65
    v_mov_b32 v170, v66
    v_mov_b32 v171, v67
    v_mov_b32 v172, v80
    v_mov_b32 v173, v81
    v_mov_b32 v174, v82
    v_mov_b32 v175, v83
K2_donew0:
    s_cmp_eq_u32 s33, 1
    s_cbranch_scc1 K2_skipw1
    ds_write_b128 v4, v[20:23] offset:5120
    ds_write_b128 v4, v[36:39] offset:6144
    ds_write_b128 v4, v[52:55] offset:7168
    ds_write_b128 v4, v[68:71] offset:8192
    ds_write_b128 v4, v[84:87] offset:9216
    s_branch K2_donew1
K2_skipw1:
    v_mov_b32 v156, v20
    v_mov_b32 v157, v21
    v_mov_b32 v158, v22
    v_mov_b32 v159, v23
    v_mov_b32 v160, v36
    v_mov_b32 v161, v37
    v_mov_b32 v162, v38
    v_mov_b32 v163, v39
    v_mov_b32 v164, v52
    v_mov_b32 v165, v53
    v_mov_b32 v166, v54
    v_mov_b32 v167, v55
    v_mov_b32 v168, v68
    v_mov_b32 v169, v69
    v_mov_b32 v170, v70
    v_mov_b32 v171, v71
    v_mov_b32 v172, v84
    v_mov_b32 v173, v85
    v_mov_b32 v174, v86
    v_mov_b32 v175, v87
K2_donew1:
    s_cmp_eq_u32 s33, 2
    s_cbranch_scc1 K2_skipw2
    ds_write_b128 v4, v[24:27] offset:10240
    ds_write_b128 v4, v[40:43] offset:11264
    ds_write_b128 v4, v[56:59] offset:12288
    ds_write_b128 v4, v[72:75] offset:13312
    ds_write_b128 v4, v[88:91] offset:14336
    s_branch K2_donew2
K2_skipw2:
    v_mov_b32 v156, v24
    v_mov_b32 v157, v25
    v_mov_b32 v158, v26
    v_mov_b32 v159, v27
    v_mov_b32 v160, v40
    v_mov_b32 v161, v41
    v_mov_b32 v162, v42
    v_mov_b32 v163, v43
    v_mov_b32 v164, v56
    v_mov_b32 v165, v57
    v_mov_b32 v166, v58
    v_mov_b32 v167, v59
    v_mov_b32 v168, v72
    v_mov_b32 v169, v73
    v_mov_b32 v170, v74
    v_mov_b32 v171, v75
    v_mov_b32 v172, v88
    v_mov_b32 v173, v89
    v_mov_b32 v174, v90
    v_mov_b32 v175, v91
K2_donew2:
    s_cmp_eq_u32 s33, 3
    s_cbranch_scc1 K2_skipw3
    ds_write_b128 v4, v[28:31] offset:15360
    ds_write_b128 v4, v[44:47] offset:16384
    ds_write_b128 v4, v[60:63] offset:17408
    ds_write_b128 v4, v[76:79] offset:18432
    ds_write_b128 v4, v[92:95] offset:19456
    s_branch K2_donew3
K2_skipw3:
    v_mov_b32 v156, v28
    v_mov_b32 v157, v29
    v_mov_b32 v158, v30
    v_mov_b32 v159, v31
    v_mov_b32 v160, v44
    v_mov_b32 v161, v45
    v_mov_b32 v162, v46
    v_mov_b32 v163, v47
    v_mov_b32 v164, v60
    v_mov_b32 v165, v61
    v_mov_b32 v166, v62
    v_mov_b32 v167, v63
    v_mov_b32 v168, v76
    v_mov_b32 v169, v77
    v_mov_b32 v170, v78
    v_mov_b32 v171, v79
    v_mov_b32 v172, v92
    v_mov_b32 v173, v93
    v_mov_b32 v174, v94
    v_mov_b32 v175, v95
K2_donew3:
    s_lshl_b32 s45, s33, 4
    s_add_u32 s45, s45, s36
    s_mul_i32 s45, s45, 1280
    s_mul_i32 s46, s35, 160
    s_add_u32 s45, s45, s46
    s_movk_i32 s37, 1280
    v_mul_lo_u32 v5, v1, s37
    v_and_b32 v6, 1, v2
    v_lshlrev_b32 v6, 5, v6
    v_lshrrev_b32 v7, 1, v2
    v_lshl_add_u32 v6, v7, 4, v6
    v_add_u32 v6, v6, v5
    v_lshl_add_u32 v7, v2, 3, v5
    s_mul_i32 s46, s33, 5120
    s_add_u32 s46, s46, 46592
    s_add_u32 s47, s33, 1
    s_and_b32 s47, s47, 3
    s_mul_i32 s47, s47, 20480
    s_add_u32 s47, s47, s46
    v_add_u32 v9, s47, v240
    s_add_u32 s47, s33, 2
    s_and_b32 s47, s47, 3
    s_mul_i32 s47, s47, 20480
    s_add_u32 s47, s47, s46
    v_add_u32 v10, s47, v240
    s_add_u32 s47, s33, 3
    s_and_b32 s47, s47, 3
    s_mul_i32 s47, s47, 20480
    s_add_u32 s47, s47, s46
    v_add_u32 v11, s47, v240
    s_waitcnt lgkmcnt(0)
    s_barrier
    ds_read_b128 v[96:99], v9 offset:0
    ds_read_b128 v[100:103], v9 offset:1024
    ds_read_b128 v[104:107], v9 offset:2048
    ds_read_b128 v[108:111], v9 offset:3072
    ds_read_b128 v[112:115], v9 offset:4096
    ds_read_b128 v[116:119], v10 offset:0
    ds_read_b128 v[120:123], v10 offset:1024
    ds_read_b128 v[124:127], v10 offset:2048
    ds_read_b128 v[128:131], v10 offset:3072
    ds_read_b128 v[132:135], v10 offset:4096
    ds_read_b128 v[136:139], v11 offset:0
    ds_read_b128 v[140:143], v11 offset:1024
    ds_read_b128 v[144:147], v11 offset:2048
    ds_read_b128 v[148:151], v11 offset:3072
    ds_read_b128 v[152:155], v11 offset:4096

    s_waitcnt lgkmcnt(0)
    v_add_f32 v96, v96, v116
    v_add_f32 v136, v136, v156
    v_add_f32 v96, v96, v136
    v_add_f32 v97, v97, v117
    v_add_f32 v137, v137, v157
    v_add_f32 v97, v97, v137
    v_add_f32 v98, v98, v118
    v_add_f32 v138, v138, v158
    v_add_f32 v98, v98, v138
    v_add_f32 v99, v99, v119
    v_add_f32 v139, v139, v159
    v_add_f32 v99, v99, v139
    v_add_f32 v100, v100, v120
    v_add_f32 v140, v140, v160
    v_add_f32 v100, v100, v140
    v_add_f32 v101, v101, v121
    v_add_f32 v141, v141, v161
    v_add_f32 v101, v101, v141
    v_add_f32 v102, v102, v122
    v_add_f32 v142, v142, v162
    v_add_f32 v102, v102, v142
    v_add_f32 v103, v103, v123
    v_add_f32 v143, v143, v163
    v_add_f32 v103, v103, v143
    v_add_f32 v104, v104, v124
    v_add_f32 v144, v144, v164
    v_add_f32 v104, v104, v144
    v_add_f32 v105, v105, v125
    v_add_f32 v145, v145, v165
    v_add_f32 v105, v105, v145
    v_add_f32 v106, v106, v126
    v_add_f32 v146, v146, v166
    v_add_f32 v106, v106, v146
    v_add_f32 v107, v107, v127
    v_add_f32 v147, v147, v167
    v_add_f32 v107, v107, v147
    v_add_f32 v108, v108, v128
    v_add_f32 v148, v148, v168
    v_add_f32 v108, v108, v148
    v_add_f32 v109, v109, v129
    v_add_f32 v149, v149, v169
    v_add_f32 v109, v109, v149
    v_add_f32 v110, v110, v130
    v_add_f32 v150, v150, v170
    v_add_f32 v110, v110, v150
    v_add_f32 v111, v111, v131
    v_add_f32 v151, v151, v171
    v_add_f32 v111, v111, v151
    v_add_f32 v112, v112, v132
    v_add_f32 v152, v152, v172
    v_add_f32 v112, v112, v152
    v_add_f32 v113, v113, v133
    v_add_f32 v153, v153, v173
    v_add_f32 v113, v113, v153
    v_add_f32 v114, v114, v134
    v_add_f32 v154, v154, v174
    v_add_f32 v114, v114, v154
    v_add_f32 v115, v115, v135
    v_add_f32 v155, v155, v175
    v_add_f32 v115, v115, v155
    v_cvt_pk_bf16_f32 v16, v96, v97
    v_cvt_pk_bf16_f32 v17, v98, v99
    v_cvt_pk_bf16_f32 v18, v100, v101
    v_cvt_pk_bf16_f32 v19, v102, v103
    s_nop 0
    v_permlane16_swap_b32 v16, v18
    v_permlane16_swap_b32 v17, v19
    buffer_store_dwordx4 v[16:19], v6, s[20:23], s45 offen offset:0
    v_cvt_pk_bf16_f32 v20, v104, v105
    v_cvt_pk_bf16_f32 v21, v106, v107
    v_cvt_pk_bf16_f32 v22, v108, v109
    v_cvt_pk_bf16_f32 v23, v110, v111
    s_nop 0
    v_permlane16_swap_b32 v20, v22
    v_permlane16_swap_b32 v21, v23
    buffer_store_dwordx4 v[20:23], v6, s[20:23], s45 offen offset:64
    v_cvt_pk_bf16_f32 v24, v112, v113
    v_cvt_pk_bf16_f32 v25, v114, v115
    buffer_store_dwordx2 v[24:25], v7, s[20:23], s45 offen offset:128
KF_done:
    s_endpgm
K2_fallback:
    v_add_u32 v116, 4294955008, v116
    v_add_u32 v117, 4294955008, v117
    v_add_u32 v118, 4294956544, v118
    v_add_u32 v119, 4294956544, v119
    v_mov_b32 v10, 0xff7fffff
    v_mov_b32 v11, 0xff7fffff
    v_mov_b32 v96, 0
    v_mov_b32 v97, 0
    v_mov_b32 v98, 0
    v_mov_b32 v99, 0
    v_mov_b32 v100, 0
    v_mov_b32 v101, 0
    v_mov_b32 v102, 0
    v_mov_b32 v103, 0
    v_mov_b32 v104, 0
    v_mov_b32 v105, 0
    v_mov_b32 v106, 0
    v_mov_b32 v107, 0
    v_mov_b32 v108, 0
    v_mov_b32 v109, 0
    v_mov_b32 v110, 0
    v_mov_b32 v111, 0
    ds_read2st64_b64 v[48:51], v116 offset0:0 offset1:1
    ds_read2st64_b64 v[52:55], v117 offset0:0 offset1:1
    ds_read_b128 v[64:67], v118
    ds_read_b128 v[68:71], v119
    v_add_u32 v116, 1536, v116
    v_add_u32 v117, 1536, v117
    v_add_u32 v118, 1344, v118
    v_add_u32 v119, 1344, v119
    s_waitcnt lgkmcnt(0)
    v_mfma_f32_16x16x32_bf16 v[16:19], v[48:51], v[80:83], 0
    v_mfma_f32_16x16x32_bf16 v[20:23], v[52:55], v[80:83], 0
    v_mfma_f32_16x16x32_bf16 v[28:31], v[52:55], v[84:87], 0
    s_nop 7
    v_cndmask_b32 v16, v14, v16, s[44:45]
    v_cndmask_b32 v17, v14, v17, s[46:47]
    v_cndmask_b32 v18, v14, v18, s[48:49]
    v_cndmask_b32 v19, v14, v19, s[50:51]
    v_mov_b32 v5, v10
    v_max_f32 v5, v5, v16
    v_max_f32 v5, v5, v17
    v_max_f32 v5, v5, v18
    v_max_f32 v5, v5, v19
    v_max_f32 v5, v5, v20
    v_max_f32 v5, v5, v21
    v_max_f32 v5, v5, v22
    v_max_f32 v5, v5, v23
    v_mov_b32 v6, v5
    s_nop 1
    v_permlane16_swap_b32 v6, v5
    v_max_f32 v5, v5, v6
    v_mov_b32 v6, v5
    s_nop 1
    v_permlane32_swap_b32 v6, v5
    v_max_f32 v5, v5, v6
    v_sub_f32 v6, v10, v5
    v_exp_f32 v6, v6
    v_mov_b32 v10, v5
    v_mul_f32 v96, v96, v6
    v_mul_f32 v97, v97, v6
    v_mul_f32 v98, v98, v6
    v_mul_f32 v99, v99, v6
    v_mul_f32 v100, v100, v6
    v_mul_f32 v101, v101, v6
    v_mul_f32 v102, v102, v6
    v_mul_f32 v103, v103, v6
    v_sub_f32 v16, v16, v5
    v_exp_f32 v16, v16
    v_sub_f32 v17, v17, v5
    v_exp_f32 v17, v17
    v_sub_f32 v18, v18, v5
    v_exp_f32 v18, v18
    v_sub_f32 v19, v19, v5
    v_exp_f32 v19, v19
    v_sub_f32 v20, v20, v5
    v_exp_f32 v20, v20
    v_sub_f32 v21, v21, v5
    v_exp_f32 v21, v21
    v_sub_f32 v22, v22, v5
    v_exp_f32 v22, v22
    v_sub_f32 v23, v23, v5
    v_exp_f32 v23, v23
    v_cvt_pk_bf16_f32 v16, v16, v17
    v_cvt_pk_bf16_f32 v17, v18, v19
    v_cvt_pk_bf16_f32 v18, v20, v21
    v_cvt_pk_bf16_f32 v19, v22, v23
    s_nop 1
    v_mfma_f32_16x16x32_bf16 v[96:99], v[64:67], v[16:19], v[96:99]
    v_mfma_f32_16x16x32_bf16 v[100:103], v[68:71], v[16:19], v[100:103]
    s_nop 7
    v_cndmask_b32 v28, v14, v28, s[44:45]
    v_cndmask_b32 v29, v14, v29, s[46:47]
    v_cndmask_b32 v30, v14, v30, s[48:49]
    v_cndmask_b32 v31, v14, v31, s[50:51]
    v_mov_b32 v5, v11
    v_max_f32 v5, v5, v28
    v_max_f32 v5, v5, v29
    v_max_f32 v5, v5, v30
    v_max_f32 v5, v5, v31
    v_mov_b32 v6, v5
    s_nop 1
    v_permlane16_swap_b32 v6, v5
    v_max_f32 v5, v5, v6
    v_mov_b32 v6, v5
    s_nop 1
    v_permlane32_swap_b32 v6, v5
    v_max_f32 v5, v5, v6
    v_sub_f32 v6, v11, v5
    v_exp_f32 v6, v6
    v_mov_b32 v11, v5
    v_mul_f32 v104, v104, v6
    v_mul_f32 v105, v105, v6
    v_mul_f32 v106, v106, v6
    v_mul_f32 v107, v107, v6
    v_mul_f32 v108, v108, v6
    v_mul_f32 v109, v109, v6
    v_mul_f32 v110, v110, v6
    v_mul_f32 v111, v111, v6
    v_sub_f32 v28, v28, v5
    v_exp_f32 v28, v28
    v_sub_f32 v29, v29, v5
    v_exp_f32 v29, v29
    v_sub_f32 v30, v30, v5
    v_exp_f32 v30, v30
    v_sub_f32 v31, v31, v5
    v_exp_f32 v31, v31
    v_mov_b32 v24, 0
    v_mov_b32 v25, 0
    v_cvt_pk_bf16_f32 v26, v28, v29
    v_cvt_pk_bf16_f32 v27, v30, v31
    s_nop 1
    v_mfma_f32_16x16x32_bf16 v[104:107], v[64:67], v[24:27], v[104:107]
    v_mfma_f32_16x16x32_bf16 v[108:111], v[68:71], v[24:27], v[108:111]
    s_nop 7
    ds_read2st64_b64 v[48:51], v116 offset0:0 offset1:1
    ds_read2st64_b64 v[52:55], v117 offset0:0 offset1:1
    ds_read_b128 v[64:67], v118
    ds_read_b128 v[68:71], v119
    v_add_u32 v116, 1536, v116
    v_add_u32 v117, 1536, v117
    v_add_u32 v118, 1344, v118
    v_add_u32 v119, 1344, v119
    s_waitcnt lgkmcnt(0)
    v_mfma_f32_16x16x32_bf16 v[16:19], v[48:51], v[80:83], 0
    v_mfma_f32_16x16x32_bf16 v[20:23], v[52:55], v[80:83], 0
    v_mfma_f32_16x16x32_bf16 v[24:27], v[48:51], v[84:87], 0
    v_mfma_f32_16x16x32_bf16 v[28:31], v[52:55], v[84:87], 0
    s_nop 7
    v_mov_b32 v5, v10
    v_max_f32 v5, v5, v16
    v_max_f32 v5, v5, v17
    v_max_f32 v5, v5, v18
    v_max_f32 v5, v5, v19
    v_max_f32 v5, v5, v20
    v_max_f32 v5, v5, v21
    v_max_f32 v5, v5, v22
    v_max_f32 v5, v5, v23
    v_mov_b32 v6, v5
    s_nop 1
    v_permlane16_swap_b32 v6, v5
    v_max_f32 v5, v5, v6
    v_mov_b32 v6, v5
    s_nop 1
    v_permlane32_swap_b32 v6, v5
    v_max_f32 v5, v5, v6
    v_sub_f32 v6, v10, v5
    v_exp_f32 v6, v6
    v_mov_b32 v10, v5
    v_mul_f32 v96, v96, v6
    v_mul_f32 v97, v97, v6
    v_mul_f32 v98, v98, v6
    v_mul_f32 v99, v99, v6
    v_mul_f32 v100, v100, v6
    v_mul_f32 v101, v101, v6
    v_mul_f32 v102, v102, v6
    v_mul_f32 v103, v103, v6
    v_sub_f32 v16, v16, v5
    v_exp_f32 v16, v16
    v_sub_f32 v17, v17, v5
    v_exp_f32 v17, v17
    v_sub_f32 v18, v18, v5
    v_exp_f32 v18, v18
    v_sub_f32 v19, v19, v5
    v_exp_f32 v19, v19
    v_sub_f32 v20, v20, v5
    v_exp_f32 v20, v20
    v_sub_f32 v21, v21, v5
    v_exp_f32 v21, v21
    v_sub_f32 v22, v22, v5
    v_exp_f32 v22, v22
    v_sub_f32 v23, v23, v5
    v_exp_f32 v23, v23
    v_cvt_pk_bf16_f32 v16, v16, v17
    v_cvt_pk_bf16_f32 v17, v18, v19
    v_cvt_pk_bf16_f32 v18, v20, v21
    v_cvt_pk_bf16_f32 v19, v22, v23
    s_nop 1
    v_mfma_f32_16x16x32_bf16 v[96:99], v[64:67], v[16:19], v[96:99]
    v_mfma_f32_16x16x32_bf16 v[100:103], v[68:71], v[16:19], v[100:103]
    s_nop 7
    v_mov_b32 v5, v11
    v_max_f32 v5, v5, v24
    v_max_f32 v5, v5, v25
    v_max_f32 v5, v5, v26
    v_max_f32 v5, v5, v27
    v_max_f32 v5, v5, v28
    v_max_f32 v5, v5, v29
    v_max_f32 v5, v5, v30
    v_max_f32 v5, v5, v31
    v_mov_b32 v6, v5
    s_nop 1
    v_permlane16_swap_b32 v6, v5
    v_max_f32 v5, v5, v6
    v_mov_b32 v6, v5
    s_nop 1
    v_permlane32_swap_b32 v6, v5
    v_max_f32 v5, v5, v6
    v_sub_f32 v6, v11, v5
    v_exp_f32 v6, v6
    v_mov_b32 v11, v5
    v_mul_f32 v104, v104, v6
    v_mul_f32 v105, v105, v6
    v_mul_f32 v106, v106, v6
    v_mul_f32 v107, v107, v6
    v_mul_f32 v108, v108, v6
    v_mul_f32 v109, v109, v6
    v_mul_f32 v110, v110, v6
    v_mul_f32 v111, v111, v6
    v_sub_f32 v24, v24, v5
    v_exp_f32 v24, v24
    v_sub_f32 v25, v25, v5
    v_exp_f32 v25, v25
    v_sub_f32 v26, v26, v5
    v_exp_f32 v26, v26
    v_sub_f32 v27, v27, v5
    v_exp_f32 v27, v27
    v_sub_f32 v28, v28, v5
    v_exp_f32 v28, v28
    v_sub_f32 v29, v29, v5
    v_exp_f32 v29, v29
    v_sub_f32 v30, v30, v5
    v_exp_f32 v30, v30
    v_sub_f32 v31, v31, v5
    v_exp_f32 v31, v31
    v_cvt_pk_bf16_f32 v24, v24, v25
    v_cvt_pk_bf16_f32 v25, v26, v27
    v_cvt_pk_bf16_f32 v26, v28, v29
    v_cvt_pk_bf16_f32 v27, v30, v31
    s_nop 1
    v_mfma_f32_16x16x32_bf16 v[104:107], v[64:67], v[24:27], v[104:107]
    v_mfma_f32_16x16x32_bf16 v[108:111], v[68:71], v[24:27], v[108:111]
    s_nop 7
    ds_read2st64_b64 v[48:51], v116 offset0:0 offset1:1
    ds_read2st64_b64 v[52:55], v117 offset0:0 offset1:1
    ds_read_b128 v[64:67], v118
    ds_read_b128 v[68:71], v119
    v_add_u32 v116, 1536, v116
    v_add_u32 v117, 1536, v117
    v_add_u32 v118, 1344, v118
    v_add_u32 v119, 1344, v119
    s_waitcnt lgkmcnt(0)
    v_mfma_f32_16x16x32_bf16 v[16:19], v[48:51], v[80:83], 0
    v_mfma_f32_16x16x32_bf16 v[20:23], v[52:55], v[80:83], 0
    v_mfma_f32_16x16x32_bf16 v[24:27], v[48:51], v[84:87], 0
    v_mfma_f32_16x16x32_bf16 v[28:31], v[52:55], v[84:87], 0
    s_nop 7
    v_mov_b32 v5, v10
    v_max_f32 v5, v5, v16
    v_max_f32 v5, v5, v17
    v_max_f32 v5, v5, v18
    v_max_f32 v5, v5, v19
    v_max_f32 v5, v5, v20
    v_max_f32 v5, v5, v21
    v_max_f32 v5, v5, v22
    v_max_f32 v5, v5, v23
    v_mov_b32 v6, v5
    s_nop 1
    v_permlane16_swap_b32 v6, v5
    v_max_f32 v5, v5, v6
    v_mov_b32 v6, v5
    s_nop 1
    v_permlane32_swap_b32 v6, v5
    v_max_f32 v5, v5, v6
    v_sub_f32 v6, v10, v5
    v_exp_f32 v6, v6
    v_mov_b32 v10, v5
    v_mul_f32 v96, v96, v6
    v_mul_f32 v97, v97, v6
    v_mul_f32 v98, v98, v6
    v_mul_f32 v99, v99, v6
    v_mul_f32 v100, v100, v6
    v_mul_f32 v101, v101, v6
    v_mul_f32 v102, v102, v6
    v_mul_f32 v103, v103, v6
    v_sub_f32 v16, v16, v5
    v_exp_f32 v16, v16
    v_sub_f32 v17, v17, v5
    v_exp_f32 v17, v17
    v_sub_f32 v18, v18, v5
    v_exp_f32 v18, v18
    v_sub_f32 v19, v19, v5
    v_exp_f32 v19, v19
    v_sub_f32 v20, v20, v5
    v_exp_f32 v20, v20
    v_sub_f32 v21, v21, v5
    v_exp_f32 v21, v21
    v_sub_f32 v22, v22, v5
    v_exp_f32 v22, v22
    v_sub_f32 v23, v23, v5
    v_exp_f32 v23, v23
    v_cvt_pk_bf16_f32 v16, v16, v17
    v_cvt_pk_bf16_f32 v17, v18, v19
    v_cvt_pk_bf16_f32 v18, v20, v21
    v_cvt_pk_bf16_f32 v19, v22, v23
    s_nop 1
    v_mfma_f32_16x16x32_bf16 v[96:99], v[64:67], v[16:19], v[96:99]
    v_mfma_f32_16x16x32_bf16 v[100:103], v[68:71], v[16:19], v[100:103]
    s_nop 7
    v_mov_b32 v5, v11
    v_max_f32 v5, v5, v24
    v_max_f32 v5, v5, v25
    v_max_f32 v5, v5, v26
    v_max_f32 v5, v5, v27
    v_max_f32 v5, v5, v28
    v_max_f32 v5, v5, v29
    v_max_f32 v5, v5, v30
    v_max_f32 v5, v5, v31
    v_mov_b32 v6, v5
    s_nop 1
    v_permlane16_swap_b32 v6, v5
    v_max_f32 v5, v5, v6
    v_mov_b32 v6, v5
    s_nop 1
    v_permlane32_swap_b32 v6, v5
    v_max_f32 v5, v5, v6
    v_sub_f32 v6, v11, v5
    v_exp_f32 v6, v6
    v_mov_b32 v11, v5
    v_mul_f32 v104, v104, v6
    v_mul_f32 v105, v105, v6
    v_mul_f32 v106, v106, v6
    v_mul_f32 v107, v107, v6
    v_mul_f32 v108, v108, v6
    v_mul_f32 v109, v109, v6
    v_mul_f32 v110, v110, v6
    v_mul_f32 v111, v111, v6
    v_sub_f32 v24, v24, v5
    v_exp_f32 v24, v24
    v_sub_f32 v25, v25, v5
    v_exp_f32 v25, v25
    v_sub_f32 v26, v26, v5
    v_exp_f32 v26, v26
    v_sub_f32 v27, v27, v5
    v_exp_f32 v27, v27
    v_sub_f32 v28, v28, v5
    v_exp_f32 v28, v28
    v_sub_f32 v29, v29, v5
    v_exp_f32 v29, v29
    v_sub_f32 v30, v30, v5
    v_exp_f32 v30, v30
    v_sub_f32 v31, v31, v5
    v_exp_f32 v31, v31
    v_cvt_pk_bf16_f32 v24, v24, v25
    v_cvt_pk_bf16_f32 v25, v26, v27
    v_cvt_pk_bf16_f32 v26, v28, v29
    v_cvt_pk_bf16_f32 v27, v30, v31
    s_nop 1
    v_mfma_f32_16x16x32_bf16 v[104:107], v[64:67], v[24:27], v[104:107]
    v_mfma_f32_16x16x32_bf16 v[108:111], v[68:71], v[24:27], v[108:111]
    s_nop 7
    ds_read2st64_b64 v[48:51], v116 offset0:0 offset1:1
    ds_read2st64_b64 v[52:55], v117 offset0:0 offset1:1
    ds_read_b128 v[64:67], v118
    ds_read_b128 v[68:71], v119
    v_add_u32 v116, 1536, v116
    v_add_u32 v117, 1536, v117
    v_add_u32 v118, 1344, v118
    v_add_u32 v119, 1344, v119
    s_waitcnt lgkmcnt(0)
    v_mfma_f32_16x16x32_bf16 v[16:19], v[48:51], v[80:83], 0
    v_mfma_f32_16x16x32_bf16 v[20:23], v[52:55], v[80:83], 0
    v_mfma_f32_16x16x32_bf16 v[24:27], v[48:51], v[84:87], 0
    v_mfma_f32_16x16x32_bf16 v[28:31], v[52:55], v[84:87], 0
    s_nop 7
    v_mov_b32 v5, v10
    v_max_f32 v5, v5, v16
    v_max_f32 v5, v5, v17
    v_max_f32 v5, v5, v18
    v_max_f32 v5, v5, v19
    v_max_f32 v5, v5, v20
    v_max_f32 v5, v5, v21
    v_max_f32 v5, v5, v22
    v_max_f32 v5, v5, v23
    v_mov_b32 v6, v5
    s_nop 1
    v_permlane16_swap_b32 v6, v5
    v_max_f32 v5, v5, v6
    v_mov_b32 v6, v5
    s_nop 1
    v_permlane32_swap_b32 v6, v5
    v_max_f32 v5, v5, v6
    v_sub_f32 v6, v10, v5
    v_exp_f32 v6, v6
    v_mov_b32 v10, v5
    v_mul_f32 v96, v96, v6
    v_mul_f32 v97, v97, v6
    v_mul_f32 v98, v98, v6
    v_mul_f32 v99, v99, v6
    v_mul_f32 v100, v100, v6
    v_mul_f32 v101, v101, v6
    v_mul_f32 v102, v102, v6
    v_mul_f32 v103, v103, v6
    v_sub_f32 v16, v16, v5
    v_exp_f32 v16, v16
    v_sub_f32 v17, v17, v5
    v_exp_f32 v17, v17
    v_sub_f32 v18, v18, v5
    v_exp_f32 v18, v18
    v_sub_f32 v19, v19, v5
    v_exp_f32 v19, v19
    v_sub_f32 v20, v20, v5
    v_exp_f32 v20, v20
    v_sub_f32 v21, v21, v5
    v_exp_f32 v21, v21
    v_sub_f32 v22, v22, v5
    v_exp_f32 v22, v22
    v_sub_f32 v23, v23, v5
    v_exp_f32 v23, v23
    v_cvt_pk_bf16_f32 v16, v16, v17
    v_cvt_pk_bf16_f32 v17, v18, v19
    v_cvt_pk_bf16_f32 v18, v20, v21
    v_cvt_pk_bf16_f32 v19, v22, v23
    s_nop 1
    v_mfma_f32_16x16x32_bf16 v[96:99], v[64:67], v[16:19], v[96:99]
    v_mfma_f32_16x16x32_bf16 v[100:103], v[68:71], v[16:19], v[100:103]
    s_nop 7
    v_mov_b32 v5, v11
    v_max_f32 v5, v5, v24
    v_max_f32 v5, v5, v25
    v_max_f32 v5, v5, v26
    v_max_f32 v5, v5, v27
    v_max_f32 v5, v5, v28
    v_max_f32 v5, v5, v29
    v_max_f32 v5, v5, v30
    v_max_f32 v5, v5, v31
    v_mov_b32 v6, v5
    s_nop 1
    v_permlane16_swap_b32 v6, v5
    v_max_f32 v5, v5, v6
    v_mov_b32 v6, v5
    s_nop 1
    v_permlane32_swap_b32 v6, v5
    v_max_f32 v5, v5, v6
    v_sub_f32 v6, v11, v5
    v_exp_f32 v6, v6
    v_mov_b32 v11, v5
    v_mul_f32 v104, v104, v6
    v_mul_f32 v105, v105, v6
    v_mul_f32 v106, v106, v6
    v_mul_f32 v107, v107, v6
    v_mul_f32 v108, v108, v6
    v_mul_f32 v109, v109, v6
    v_mul_f32 v110, v110, v6
    v_mul_f32 v111, v111, v6
    v_sub_f32 v24, v24, v5
    v_exp_f32 v24, v24
    v_sub_f32 v25, v25, v5
    v_exp_f32 v25, v25
    v_sub_f32 v26, v26, v5
    v_exp_f32 v26, v26
    v_sub_f32 v27, v27, v5
    v_exp_f32 v27, v27
    v_sub_f32 v28, v28, v5
    v_exp_f32 v28, v28
    v_sub_f32 v29, v29, v5
    v_exp_f32 v29, v29
    v_sub_f32 v30, v30, v5
    v_exp_f32 v30, v30
    v_sub_f32 v31, v31, v5
    v_exp_f32 v31, v31
    v_cvt_pk_bf16_f32 v24, v24, v25
    v_cvt_pk_bf16_f32 v25, v26, v27
    v_cvt_pk_bf16_f32 v26, v28, v29
    v_cvt_pk_bf16_f32 v27, v30, v31
    s_nop 1
    v_mfma_f32_16x16x32_bf16 v[104:107], v[64:67], v[24:27], v[104:107]
    v_mfma_f32_16x16x32_bf16 v[108:111], v[68:71], v[24:27], v[108:111]
    s_nop 7
    ds_read2st64_b64 v[48:51], v116 offset0:0 offset1:1
    ds_read2st64_b64 v[52:55], v117 offset0:0 offset1:1
    ds_read_b128 v[64:67], v118
    ds_read_b128 v[68:71], v119
    v_add_u32 v116, 1536, v116
    v_add_u32 v117, 1536, v117
    v_add_u32 v118, 1344, v118
    v_add_u32 v119, 1344, v119
    s_waitcnt lgkmcnt(0)
    v_mfma_f32_16x16x32_bf16 v[16:19], v[48:51], v[80:83], 0
    v_mfma_f32_16x16x32_bf16 v[20:23], v[52:55], v[80:83], 0
    v_mfma_f32_16x16x32_bf16 v[24:27], v[48:51], v[84:87], 0
    v_mfma_f32_16x16x32_bf16 v[28:31], v[52:55], v[84:87], 0
    s_nop 7
    v_mov_b32 v5, v10
    v_max_f32 v5, v5, v16
    v_max_f32 v5, v5, v17
    v_max_f32 v5, v5, v18
    v_max_f32 v5, v5, v19
    v_max_f32 v5, v5, v20
    v_max_f32 v5, v5, v21
    v_max_f32 v5, v5, v22
    v_max_f32 v5, v5, v23
    v_mov_b32 v6, v5
    s_nop 1
    v_permlane16_swap_b32 v6, v5
    v_max_f32 v5, v5, v6
    v_mov_b32 v6, v5
    s_nop 1
    v_permlane32_swap_b32 v6, v5
    v_max_f32 v5, v5, v6
    v_sub_f32 v6, v10, v5
    v_exp_f32 v6, v6
    v_mov_b32 v10, v5
    v_mul_f32 v96, v96, v6
    v_mul_f32 v97, v97, v6
    v_mul_f32 v98, v98, v6
    v_mul_f32 v99, v99, v6
    v_mul_f32 v100, v100, v6
    v_mul_f32 v101, v101, v6
    v_mul_f32 v102, v102, v6
    v_mul_f32 v103, v103, v6
    v_sub_f32 v16, v16, v5
    v_exp_f32 v16, v16
    v_sub_f32 v17, v17, v5
    v_exp_f32 v17, v17
    v_sub_f32 v18, v18, v5
    v_exp_f32 v18, v18
    v_sub_f32 v19, v19, v5
    v_exp_f32 v19, v19
    v_sub_f32 v20, v20, v5
    v_exp_f32 v20, v20
    v_sub_f32 v21, v21, v5
    v_exp_f32 v21, v21
    v_sub_f32 v22, v22, v5
    v_exp_f32 v22, v22
    v_sub_f32 v23, v23, v5
    v_exp_f32 v23, v23
    v_cvt_pk_bf16_f32 v16, v16, v17
    v_cvt_pk_bf16_f32 v17, v18, v19
    v_cvt_pk_bf16_f32 v18, v20, v21
    v_cvt_pk_bf16_f32 v19, v22, v23
    s_nop 1
    v_mfma_f32_16x16x32_bf16 v[96:99], v[64:67], v[16:19], v[96:99]
    v_mfma_f32_16x16x32_bf16 v[100:103], v[68:71], v[16:19], v[100:103]
    s_nop 7
    v_mov_b32 v5, v11
    v_max_f32 v5, v5, v24
    v_max_f32 v5, v5, v25
    v_max_f32 v5, v5, v26
    v_max_f32 v5, v5, v27
    v_max_f32 v5, v5, v28
    v_max_f32 v5, v5, v29
    v_max_f32 v5, v5, v30
    v_max_f32 v5, v5, v31
    v_mov_b32 v6, v5
    s_nop 1
    v_permlane16_swap_b32 v6, v5
    v_max_f32 v5, v5, v6
    v_mov_b32 v6, v5
    s_nop 1
    v_permlane32_swap_b32 v6, v5
    v_max_f32 v5, v5, v6
    v_sub_f32 v6, v11, v5
    v_exp_f32 v6, v6
    v_mov_b32 v11, v5
    v_mul_f32 v104, v104, v6
    v_mul_f32 v105, v105, v6
    v_mul_f32 v106, v106, v6
    v_mul_f32 v107, v107, v6
    v_mul_f32 v108, v108, v6
    v_mul_f32 v109, v109, v6
    v_mul_f32 v110, v110, v6
    v_mul_f32 v111, v111, v6
    v_sub_f32 v24, v24, v5
    v_exp_f32 v24, v24
    v_sub_f32 v25, v25, v5
    v_exp_f32 v25, v25
    v_sub_f32 v26, v26, v5
    v_exp_f32 v26, v26
    v_sub_f32 v27, v27, v5
    v_exp_f32 v27, v27
    v_sub_f32 v28, v28, v5
    v_exp_f32 v28, v28
    v_sub_f32 v29, v29, v5
    v_exp_f32 v29, v29
    v_sub_f32 v30, v30, v5
    v_exp_f32 v30, v30
    v_sub_f32 v31, v31, v5
    v_exp_f32 v31, v31
    v_cvt_pk_bf16_f32 v24, v24, v25
    v_cvt_pk_bf16_f32 v25, v26, v27
    v_cvt_pk_bf16_f32 v26, v28, v29
    v_cvt_pk_bf16_f32 v27, v30, v31
    s_nop 1
    v_mfma_f32_16x16x32_bf16 v[104:107], v[64:67], v[24:27], v[104:107]
    v_mfma_f32_16x16x32_bf16 v[108:111], v[68:71], v[24:27], v[108:111]
    s_nop 7
    ds_read2st64_b64 v[48:51], v116 offset0:0 offset1:1
    ds_read2st64_b64 v[52:55], v117 offset0:0 offset1:1
    ds_read_b128 v[64:67], v118
    ds_read_b128 v[68:71], v119
    v_add_u32 v116, 1536, v116
    v_add_u32 v117, 1536, v117
    v_add_u32 v118, 1344, v118
    v_add_u32 v119, 1344, v119
    s_waitcnt lgkmcnt(0)
    v_mfma_f32_16x16x32_bf16 v[16:19], v[48:51], v[80:83], 0
    v_mfma_f32_16x16x32_bf16 v[20:23], v[52:55], v[80:83], 0
    v_mfma_f32_16x16x32_bf16 v[24:27], v[48:51], v[84:87], 0
    v_mfma_f32_16x16x32_bf16 v[28:31], v[52:55], v[84:87], 0
    s_nop 7
    v_mov_b32 v5, v10
    v_max_f32 v5, v5, v16
    v_max_f32 v5, v5, v17
    v_max_f32 v5, v5, v18
    v_max_f32 v5, v5, v19
    v_max_f32 v5, v5, v20
    v_max_f32 v5, v5, v21
    v_max_f32 v5, v5, v22
    v_max_f32 v5, v5, v23
    v_mov_b32 v6, v5
    s_nop 1
    v_permlane16_swap_b32 v6, v5
    v_max_f32 v5, v5, v6
    v_mov_b32 v6, v5
    s_nop 1
    v_permlane32_swap_b32 v6, v5
    v_max_f32 v5, v5, v6
    v_sub_f32 v6, v10, v5
    v_exp_f32 v6, v6
    v_mov_b32 v10, v5
    v_mul_f32 v96, v96, v6
    v_mul_f32 v97, v97, v6
    v_mul_f32 v98, v98, v6
    v_mul_f32 v99, v99, v6
    v_mul_f32 v100, v100, v6
    v_mul_f32 v101, v101, v6
    v_mul_f32 v102, v102, v6
    v_mul_f32 v103, v103, v6
    v_sub_f32 v16, v16, v5
    v_exp_f32 v16, v16
    v_sub_f32 v17, v17, v5
    v_exp_f32 v17, v17
    v_sub_f32 v18, v18, v5
    v_exp_f32 v18, v18
    v_sub_f32 v19, v19, v5
    v_exp_f32 v19, v19
    v_sub_f32 v20, v20, v5
    v_exp_f32 v20, v20
    v_sub_f32 v21, v21, v5
    v_exp_f32 v21, v21
    v_sub_f32 v22, v22, v5
    v_exp_f32 v22, v22
    v_sub_f32 v23, v23, v5
    v_exp_f32 v23, v23
    v_cvt_pk_bf16_f32 v16, v16, v17
    v_cvt_pk_bf16_f32 v17, v18, v19
    v_cvt_pk_bf16_f32 v18, v20, v21
    v_cvt_pk_bf16_f32 v19, v22, v23
    s_nop 1
    v_mfma_f32_16x16x32_bf16 v[96:99], v[64:67], v[16:19], v[96:99]
    v_mfma_f32_16x16x32_bf16 v[100:103], v[68:71], v[16:19], v[100:103]
    s_nop 7
    v_mov_b32 v5, v11
    v_max_f32 v5, v5, v24
    v_max_f32 v5, v5, v25
    v_max_f32 v5, v5, v26
    v_max_f32 v5, v5, v27
    v_max_f32 v5, v5, v28
    v_max_f32 v5, v5, v29
    v_max_f32 v5, v5, v30
    v_max_f32 v5, v5, v31
    v_mov_b32 v6, v5
    s_nop 1
    v_permlane16_swap_b32 v6, v5
    v_max_f32 v5, v5, v6
    v_mov_b32 v6, v5
    s_nop 1
    v_permlane32_swap_b32 v6, v5
    v_max_f32 v5, v5, v6
    v_sub_f32 v6, v11, v5
    v_exp_f32 v6, v6
    v_mov_b32 v11, v5
    v_mul_f32 v104, v104, v6
    v_mul_f32 v105, v105, v6
    v_mul_f32 v106, v106, v6
    v_mul_f32 v107, v107, v6
    v_mul_f32 v108, v108, v6
    v_mul_f32 v109, v109, v6
    v_mul_f32 v110, v110, v6
    v_mul_f32 v111, v111, v6
    v_sub_f32 v24, v24, v5
    v_exp_f32 v24, v24
    v_sub_f32 v25, v25, v5
    v_exp_f32 v25, v25
    v_sub_f32 v26, v26, v5
    v_exp_f32 v26, v26
    v_sub_f32 v27, v27, v5
    v_exp_f32 v27, v27
    v_sub_f32 v28, v28, v5
    v_exp_f32 v28, v28
    v_sub_f32 v29, v29, v5
    v_exp_f32 v29, v29
    v_sub_f32 v30, v30, v5
    v_exp_f32 v30, v30
    v_sub_f32 v31, v31, v5
    v_exp_f32 v31, v31
    v_cvt_pk_bf16_f32 v24, v24, v25
    v_cvt_pk_bf16_f32 v25, v26, v27
    v_cvt_pk_bf16_f32 v26, v28, v29
    v_cvt_pk_bf16_f32 v27, v30, v31
    s_nop 1
    v_mfma_f32_16x16x32_bf16 v[104:107], v[64:67], v[24:27], v[104:107]
    v_mfma_f32_16x16x32_bf16 v[108:111], v[68:71], v[24:27], v[108:111]
    s_nop 7
    ds_read2st64_b64 v[48:51], v116 offset0:0 offset1:1
    ds_read2st64_b64 v[52:55], v117 offset0:0 offset1:1
    ds_read_b128 v[64:67], v118
    ds_read_b128 v[68:71], v119
    v_add_u32 v116, 1536, v116
    v_add_u32 v117, 1536, v117
    v_add_u32 v118, 1344, v118
    v_add_u32 v119, 1344, v119
    s_waitcnt lgkmcnt(0)
    v_mfma_f32_16x16x32_bf16 v[16:19], v[48:51], v[80:83], 0
    v_mfma_f32_16x16x32_bf16 v[20:23], v[52:55], v[80:83], 0
    v_mfma_f32_16x16x32_bf16 v[24:27], v[48:51], v[84:87], 0
    v_mfma_f32_16x16x32_bf16 v[28:31], v[52:55], v[84:87], 0
    s_nop 7
    v_mov_b32 v5, v10
    v_max_f32 v5, v5, v16
    v_max_f32 v5, v5, v17
    v_max_f32 v5, v5, v18
    v_max_f32 v5, v5, v19
    v_max_f32 v5, v5, v20
    v_max_f32 v5, v5, v21
    v_max_f32 v5, v5, v22
    v_max_f32 v5, v5, v23
    v_mov_b32 v6, v5
    s_nop 1
    v_permlane16_swap_b32 v6, v5
    v_max_f32 v5, v5, v6
    v_mov_b32 v6, v5
    s_nop 1
    v_permlane32_swap_b32 v6, v5
    v_max_f32 v5, v5, v6
    v_sub_f32 v6, v10, v5
    v_exp_f32 v6, v6
    v_mov_b32 v10, v5
    v_mul_f32 v96, v96, v6
    v_mul_f32 v97, v97, v6
    v_mul_f32 v98, v98, v6
    v_mul_f32 v99, v99, v6
    v_mul_f32 v100, v100, v6
    v_mul_f32 v101, v101, v6
    v_mul_f32 v102, v102, v6
    v_mul_f32 v103, v103, v6
    v_sub_f32 v16, v16, v5
    v_exp_f32 v16, v16
    v_sub_f32 v17, v17, v5
    v_exp_f32 v17, v17
    v_sub_f32 v18, v18, v5
    v_exp_f32 v18, v18
    v_sub_f32 v19, v19, v5
    v_exp_f32 v19, v19
    v_sub_f32 v20, v20, v5
    v_exp_f32 v20, v20
    v_sub_f32 v21, v21, v5
    v_exp_f32 v21, v21
    v_sub_f32 v22, v22, v5
    v_exp_f32 v22, v22
    v_sub_f32 v23, v23, v5
    v_exp_f32 v23, v23
    v_cvt_pk_bf16_f32 v16, v16, v17
    v_cvt_pk_bf16_f32 v17, v18, v19
    v_cvt_pk_bf16_f32 v18, v20, v21
    v_cvt_pk_bf16_f32 v19, v22, v23
    s_nop 1
    v_mfma_f32_16x16x32_bf16 v[96:99], v[64:67], v[16:19], v[96:99]
    v_mfma_f32_16x16x32_bf16 v[100:103], v[68:71], v[16:19], v[100:103]
    s_nop 7
    v_mov_b32 v5, v11
    v_max_f32 v5, v5, v24
    v_max_f32 v5, v5, v25
    v_max_f32 v5, v5, v26
    v_max_f32 v5, v5, v27
    v_max_f32 v5, v5, v28
    v_max_f32 v5, v5, v29
    v_max_f32 v5, v5, v30
    v_max_f32 v5, v5, v31
    v_mov_b32 v6, v5
    s_nop 1
    v_permlane16_swap_b32 v6, v5
    v_max_f32 v5, v5, v6
    v_mov_b32 v6, v5
    s_nop 1
    v_permlane32_swap_b32 v6, v5
    v_max_f32 v5, v5, v6
    v_sub_f32 v6, v11, v5
    v_exp_f32 v6, v6
    v_mov_b32 v11, v5
    v_mul_f32 v104, v104, v6
    v_mul_f32 v105, v105, v6
    v_mul_f32 v106, v106, v6
    v_mul_f32 v107, v107, v6
    v_mul_f32 v108, v108, v6
    v_mul_f32 v109, v109, v6
    v_mul_f32 v110, v110, v6
    v_mul_f32 v111, v111, v6
    v_sub_f32 v24, v24, v5
    v_exp_f32 v24, v24
    v_sub_f32 v25, v25, v5
    v_exp_f32 v25, v25
    v_sub_f32 v26, v26, v5
    v_exp_f32 v26, v26
    v_sub_f32 v27, v27, v5
    v_exp_f32 v27, v27
    v_sub_f32 v28, v28, v5
    v_exp_f32 v28, v28
    v_sub_f32 v29, v29, v5
    v_exp_f32 v29, v29
    v_sub_f32 v30, v30, v5
    v_exp_f32 v30, v30
    v_sub_f32 v31, v31, v5
    v_exp_f32 v31, v31
    v_cvt_pk_bf16_f32 v24, v24, v25
    v_cvt_pk_bf16_f32 v25, v26, v27
    v_cvt_pk_bf16_f32 v26, v28, v29
    v_cvt_pk_bf16_f32 v27, v30, v31
    s_nop 1
    v_mfma_f32_16x16x32_bf16 v[104:107], v[64:67], v[24:27], v[104:107]
    v_mfma_f32_16x16x32_bf16 v[108:111], v[68:71], v[24:27], v[108:111]
    s_nop 7
    ds_read2st64_b64 v[48:51], v116 offset0:0 offset1:1
    ds_read2st64_b64 v[52:55], v117 offset0:0 offset1:1
    ds_read_b128 v[64:67], v118
    ds_read_b128 v[68:71], v119
    v_add_u32 v116, 1536, v116
    v_add_u32 v117, 1536, v117
    v_add_u32 v118, 1344, v118
    v_add_u32 v119, 1344, v119
    s_waitcnt lgkmcnt(0)
    v_mfma_f32_16x16x32_bf16 v[16:19], v[48:51], v[80:83], 0
    v_mfma_f32_16x16x32_bf16 v[20:23], v[52:55], v[80:83], 0
    v_mfma_f32_16x16x32_bf16 v[24:27], v[48:51], v[84:87], 0
    v_mfma_f32_16x16x32_bf16 v[28:31], v[52:55], v[84:87], 0
    s_nop 7
    v_mov_b32 v5, v10
    v_max_f32 v5, v5, v16
    v_max_f32 v5, v5, v17
    v_max_f32 v5, v5, v18
    v_max_f32 v5, v5, v19
    v_max_f32 v5, v5, v20
    v_max_f32 v5, v5, v21
    v_max_f32 v5, v5, v22
    v_max_f32 v5, v5, v23
    v_mov_b32 v6, v5
    s_nop 1
    v_permlane16_swap_b32 v6, v5
    v_max_f32 v5, v5, v6
    v_mov_b32 v6, v5
    s_nop 1
    v_permlane32_swap_b32 v6, v5
    v_max_f32 v5, v5, v6
    v_sub_f32 v6, v10, v5
    v_exp_f32 v6, v6
    v_mov_b32 v10, v5
    v_mul_f32 v96, v96, v6
    v_mul_f32 v97, v97, v6
    v_mul_f32 v98, v98, v6
    v_mul_f32 v99, v99, v6
    v_mul_f32 v100, v100, v6
    v_mul_f32 v101, v101, v6
    v_mul_f32 v102, v102, v6
    v_mul_f32 v103, v103, v6
    v_sub_f32 v16, v16, v5
    v_exp_f32 v16, v16
    v_sub_f32 v17, v17, v5
    v_exp_f32 v17, v17
    v_sub_f32 v18, v18, v5
    v_exp_f32 v18, v18
    v_sub_f32 v19, v19, v5
    v_exp_f32 v19, v19
    v_sub_f32 v20, v20, v5
    v_exp_f32 v20, v20
    v_sub_f32 v21, v21, v5
    v_exp_f32 v21, v21
    v_sub_f32 v22, v22, v5
    v_exp_f32 v22, v22
    v_sub_f32 v23, v23, v5
    v_exp_f32 v23, v23
    v_cvt_pk_bf16_f32 v16, v16, v17
    v_cvt_pk_bf16_f32 v17, v18, v19
    v_cvt_pk_bf16_f32 v18, v20, v21
    v_cvt_pk_bf16_f32 v19, v22, v23
    s_nop 1
    v_mfma_f32_16x16x32_bf16 v[96:99], v[64:67], v[16:19], v[96:99]
    v_mfma_f32_16x16x32_bf16 v[100:103], v[68:71], v[16:19], v[100:103]
    s_nop 7
    v_mov_b32 v5, v11
    v_max_f32 v5, v5, v24
    v_max_f32 v5, v5, v25
    v_max_f32 v5, v5, v26
    v_max_f32 v5, v5, v27
    v_max_f32 v5, v5, v28
    v_max_f32 v5, v5, v29
    v_max_f32 v5, v5, v30
    v_max_f32 v5, v5, v31
    v_mov_b32 v6, v5
    s_nop 1
    v_permlane16_swap_b32 v6, v5
    v_max_f32 v5, v5, v6
    v_mov_b32 v6, v5
    s_nop 1
    v_permlane32_swap_b32 v6, v5
    v_max_f32 v5, v5, v6
    v_sub_f32 v6, v11, v5
    v_exp_f32 v6, v6
    v_mov_b32 v11, v5
    v_mul_f32 v104, v104, v6
    v_mul_f32 v105, v105, v6
    v_mul_f32 v106, v106, v6
    v_mul_f32 v107, v107, v6
    v_mul_f32 v108, v108, v6
    v_mul_f32 v109, v109, v6
    v_mul_f32 v110, v110, v6
    v_mul_f32 v111, v111, v6
    v_sub_f32 v24, v24, v5
    v_exp_f32 v24, v24
    v_sub_f32 v25, v25, v5
    v_exp_f32 v25, v25
    v_sub_f32 v26, v26, v5
    v_exp_f32 v26, v26
    v_sub_f32 v27, v27, v5
    v_exp_f32 v27, v27
    v_sub_f32 v28, v28, v5
    v_exp_f32 v28, v28
    v_sub_f32 v29, v29, v5
    v_exp_f32 v29, v29
    v_sub_f32 v30, v30, v5
    v_exp_f32 v30, v30
    v_sub_f32 v31, v31, v5
    v_exp_f32 v31, v31
    v_cvt_pk_bf16_f32 v24, v24, v25
    v_cvt_pk_bf16_f32 v25, v26, v27
    v_cvt_pk_bf16_f32 v26, v28, v29
    v_cvt_pk_bf16_f32 v27, v30, v31
    s_nop 1
    v_mfma_f32_16x16x32_bf16 v[104:107], v[64:67], v[24:27], v[104:107]
    v_mfma_f32_16x16x32_bf16 v[108:111], v[68:71], v[24:27], v[108:111]
    s_nop 7
    ds_read2st64_b64 v[48:51], v116 offset0:0 offset1:1
    ds_read2st64_b64 v[52:55], v117 offset0:0 offset1:1
    ds_read_b128 v[64:67], v118
    ds_read_b128 v[68:71], v119
    s_waitcnt lgkmcnt(0)
    v_mfma_f32_16x16x32_bf16 v[16:19], v[48:51], v[80:83], 0
    v_mfma_f32_16x16x32_bf16 v[24:27], v[48:51], v[84:87], 0
    v_mfma_f32_16x16x32_bf16 v[28:31], v[52:55], v[84:87], 0
    s_nop 7
    v_cndmask_b32 v16, v16, v14, s[44:45]
    v_cndmask_b32 v17, v17, v14, s[46:47]
    v_cndmask_b32 v18, v18, v14, s[48:49]
    v_cndmask_b32 v19, v19, v14, s[50:51]
    v_mov_b32 v5, v10
    v_max_f32 v5, v5, v16
    v_max_f32 v5, v5, v17
    v_max_f32 v5, v5, v18
    v_max_f32 v5, v5, v19
    v_mov_b32 v6, v5
    s_nop 1
    v_permlane16_swap_b32 v6, v5
    v_max_f32 v5, v5, v6
    v_mov_b32 v6, v5
    s_nop 1
    v_permlane32_swap_b32 v6, v5
    v_max_f32 v5, v5, v6
    v_sub_f32 v6, v10, v5
    v_exp_f32 v6, v6
    v_mov_b32 v10, v5
    v_mul_f32 v96, v96, v6
    v_mul_f32 v97, v97, v6
    v_mul_f32 v98, v98, v6
    v_mul_f32 v99, v99, v6
    v_mul_f32 v100, v100, v6
    v_mul_f32 v101, v101, v6
    v_mul_f32 v102, v102, v6
    v_mul_f32 v103, v103, v6
    v_sub_f32 v16, v16, v5
    v_exp_f32 v16, v16
    v_sub_f32 v17, v17, v5
    v_exp_f32 v17, v17
    v_sub_f32 v18, v18, v5
    v_exp_f32 v18, v18
    v_sub_f32 v19, v19, v5
    v_exp_f32 v19, v19
    v_cvt_pk_bf16_f32 v16, v16, v17
    v_cvt_pk_bf16_f32 v17, v18, v19
    v_mov_b32 v18, 0
    v_mov_b32 v19, 0
    s_nop 1
    v_mfma_f32_16x16x32_bf16 v[96:99], v[64:67], v[16:19], v[96:99]
    v_mfma_f32_16x16x32_bf16 v[100:103], v[68:71], v[16:19], v[100:103]
    s_nop 7
    v_cndmask_b32 v28, v28, v14, s[44:45]
    v_cndmask_b32 v29, v29, v14, s[46:47]
    v_cndmask_b32 v30, v30, v14, s[48:49]
    v_cndmask_b32 v31, v31, v14, s[50:51]
    v_mov_b32 v5, v11
    v_max_f32 v5, v5, v24
    v_max_f32 v5, v5, v25
    v_max_f32 v5, v5, v26
    v_max_f32 v5, v5, v27
    v_max_f32 v5, v5, v28
    v_max_f32 v5, v5, v29
    v_max_f32 v5, v5, v30
    v_max_f32 v5, v5, v31
    v_mov_b32 v6, v5
    s_nop 1
    v_permlane16_swap_b32 v6, v5
    v_max_f32 v5, v5, v6
    v_mov_b32 v6, v5
    s_nop 1
    v_permlane32_swap_b32 v6, v5
    v_max_f32 v5, v5, v6
    v_sub_f32 v6, v11, v5
    v_exp_f32 v6, v6
    v_mov_b32 v11, v5
    v_mul_f32 v104, v104, v6
    v_mul_f32 v105, v105, v6
    v_mul_f32 v106, v106, v6
    v_mul_f32 v107, v107, v6
    v_mul_f32 v108, v108, v6
    v_mul_f32 v109, v109, v6
    v_mul_f32 v110, v110, v6
    v_mul_f32 v111, v111, v6
    v_sub_f32 v24, v24, v5
    v_exp_f32 v24, v24
    v_sub_f32 v25, v25, v5
    v_exp_f32 v25, v25
    v_sub_f32 v26, v26, v5
    v_exp_f32 v26, v26
    v_sub_f32 v27, v27, v5
    v_exp_f32 v27, v27
    v_sub_f32 v28, v28, v5
    v_exp_f32 v28, v28
    v_sub_f32 v29, v29, v5
    v_exp_f32 v29, v29
    v_sub_f32 v30, v30, v5
    v_exp_f32 v30, v30
    v_sub_f32 v31, v31, v5
    v_exp_f32 v31, v31
    v_cvt_pk_bf16_f32 v24, v24, v25
    v_cvt_pk_bf16_f32 v25, v26, v27
    v_cvt_pk_bf16_f32 v26, v28, v29
    v_cvt_pk_bf16_f32 v27, v30, v31
    s_nop 1
    v_mfma_f32_16x16x32_bf16 v[104:107], v[64:67], v[24:27], v[104:107]
    v_mfma_f32_16x16x32_bf16 v[108:111], v[68:71], v[24:27], v[108:111]
    s_nop 7
    s_nop 7
    v_mov_b32 v3, v100
    v_mov_b32 v4, v100
    s_nop 1
    v_permlane16_swap_b32 v4, v3
    v_mov_b32 v4, v3
    s_nop 1
    v_permlane32_swap_b32 v4, v3
    v_mov_b32 v5, v108
    v_mov_b32 v6, v108
    s_nop 1
    v_permlane16_swap_b32 v6, v5
    v_mov_b32 v6, v5
    s_nop 1
    v_permlane32_swap_b32 v6, v5
    s_branch K2_fin

.section .rodata,"a"
.p2align 6
.amdhsa_kernel k1_kernel
  .amdhsa_next_free_vgpr 232
  .amdhsa_next_free_sgpr 102
  .amdhsa_accum_offset 232
  .amdhsa_group_segment_fixed_size 0
  .amdhsa_kernarg_size 80
  .amdhsa_user_sgpr_count 2
  .amdhsa_user_sgpr_kernarg_segment_ptr 1
  .amdhsa_system_sgpr_workgroup_id_x 1
.end_amdhsa_kernel
.p2align 6
.amdhsa_kernel k2_kernel
  .amdhsa_next_free_vgpr 248
  .amdhsa_next_free_sgpr 102
  .amdhsa_accum_offset 248
  .amdhsa_group_segment_fixed_size 0
  .amdhsa_kernarg_size 80
  .amdhsa_user_sgpr_count 2
  .amdhsa_user_sgpr_kernarg_segment_ptr 1
  .amdhsa_system_sgpr_workgroup_id_x 1
.end_amdhsa_kernel
```
